```python
import torch

def _softmax(x, axis=-1):
    return torch.softmax(x, dim=axis)
def _gelu(x):
    return torch.nn.functional.gelu(x, approximate="tanh")
def _silu(x):
    return torch.nn.functional.silu(x)
def _sigmoid(x):
    return torch.sigmoid(x)
def _layernorm(x, axis=-1, eps=1e-5):
    m = x.mean(dim=axis, keepdim=True)
    v = x.var(dim=axis, keepdim=True, unbiased=False)
    return (x - m) / torch.sqrt(v + eps)
def _scatter_add(tgt, idx, src, axis=0):
    return tgt.clone().index_add_(axis, idx, src)
def _segment_sum(src, seg, n):
    out = torch.zeros((n,) + src.shape[1:], dtype=src.dtype)
    return out.index_add_(0, seg, src)
def _pad(x, pw):
    flat = tuple(v for pair in reversed(pw) for v in pair)
    return torch.nn.functional.pad(x, flat)

kernel_name = 'gated_mix__sliding_block__moe_arch_mod__prompt'

def setup_inputs():

    _w = (lambda a: (lambda t: t.to(torch.bfloat16) if t.is_floating_point() else t)(torch.as_tensor(a)))
    def _A_setup():
        B, S, D = 1, 2048, 640
        return {
            "x": _w((lambda *s: torch.randn(*s, dtype=torch.bfloat16) * 0.05)(B, S, D)),
            "wqkv": _w((lambda *s: torch.randn(*s, dtype=torch.bfloat16) * 1.6)(D, 3 * D)),
            "wo": _w((lambda *s: torch.randn(*s, dtype=torch.bfloat16) * 0.05)(D, D)),
        }
    _A_in = _A_setup()

    def _B_setup():
        B, S, D, F, C = 1, 2048, 640, 1536, 8
        return {
            "x": _w((lambda *s: torch.randn(*s, dtype=torch.bfloat16) * 0.05)(B, S, D)),
            "w_r": _w((lambda *s: torch.randn(*s, dtype=torch.bfloat16) * 3.2)(D)),
            "w_gate": _w((lambda *s: torch.randn(*s, dtype=torch.bfloat16) * 0.4)(D, F)),
            "w_up": _w((lambda *s: torch.randn(*s, dtype=torch.bfloat16) * 0.4)(D, F)),
            "w_down": _w((lambda *s: torch.randn(*s, dtype=torch.bfloat16) * 0.4)(F, D)),
        }
    _B_in = _B_setup()

    return {
        "A_x": _A_in["x"],
        "A_wqkv": _A_in["wqkv"],
        "A_wo": _A_in["wo"],
        "B_x": _B_in["x"],
        "B_w_r": _B_in["w_r"],
        "B_w_gate": _B_in["w_gate"],
        "B_w_up": _B_in["w_up"],
        "B_w_down": _B_in["w_down"],
        "gate_w": _w((lambda *s: torch.randn(*s, dtype=torch.bfloat16) * 0.05)(640) * 16.0),
    }

def reference(A_x, A_wqkv, A_wo, B_x, B_w_r, B_w_gate, B_w_up, B_w_down, gate_w):
    def _A_ref(x, wqkv, wo):
        B, S, D = x.shape
        H = 32; Dh = D // H; W = 256
        qkv = (lambda x, *d: x.permute(*d))((x @ wqkv).reshape(B, S, 3, H, Dh), 2, 0, 3, 1, 4)
        q, k, v = qkv[0], qkv[1], qkv[2]
        scores = torch.einsum("bhqd,bhkd->bhqk", q, k) * (Dh ** -0.5)
        idx = torch.arange(S)
        mask = (idx[:, None] - idx[None, :] >= 0) & (idx[:, None] - idx[None, :] < W)
        scores = torch.where(mask[None, None], scores, -1e9)
        p = _softmax(scores, axis=-1)
        o = torch.einsum("bhqk,bhkd->bhqd", p, v)
        return (lambda x, *d: x.permute(*d))(o, 0, 2, 1, 3).reshape(B, S, D) @ wo

    def _B_ref(x, w_r, w_gate, w_up, w_down):
        B, S, D = x.shape
        C = 8
        r = x @ w_r
        idx = torch.argsort(-r, axis=-1)[:, :C]
        idx_e = (lambda x, n, axis: torch.repeat_interleave(x, n, dim=axis))(idx.reshape(B, C, 1), D, axis=2)
        x_sel = (lambda x, i, axis: torch.take_along_dim(x, i, dim=axis))(x, idx_e, axis=1)
        g = _silu(x_sel @ w_gate)
        u = x_sel @ w_up
        y = (g * u) @ w_down
        r_sel = _sigmoid((lambda x, i, axis: torch.take_along_dim(x, i, dim=axis))(r, idx, axis=1))
        y = y * r_sel.reshape(B, C, 1)
        b_off = (torch.arange(B) * S).reshape(B, 1)
        flat_idx = (idx + b_off).reshape(B * C)
        zero = (x * 0.0).reshape(B * S, D)
        upd = _scatter_add(zero, flat_idx, y.reshape(B * C, D), axis=0)
        return x + upd.reshape(B, S, D)

    x = A_x
    g = _sigmoid((x * gate_w).sum(-1, keepdims=True))
    a = _A_ref(x, A_wqkv, A_wo)
    b = _B_ref(x, B_w_r, B_w_gate, B_w_up, B_w_down)
    return g * a + (1 - g) * b
```

```asm
; @launch grid=(256,1,1) block=(768,1,1) lds=163840
.amdgcn_target "amdgcn-amd-amdhsa--gfx950"
.text
.globl gated_mix__sliding_block__moe_arch_mod__prompt_kernel
.p2align 8
.type gated_mix__sliding_block__moe_arch_mod__prompt_kernel,@function
gated_mix__sliding_block__moe_arch_mod__prompt_kernel:
    s_load_dwordx16 s[4:19], s[0:1], 0
    s_load_dwordx8 s[20:27], s[0:1], 64
    s_cmp_ge_u32 s2, 256
    s_cbranch_scc1 K_END
    s_and_b32 s28, s2, 7
    s_lshr_b32 s29, s2, 3
    s_and_b32 s35, s29, 1
    s_lshl_b32 s32, s28, 1
    s_add_u32 s32, s32, s35
    s_lshr_b32 s33, s29, 1
    s_cmp_eq_u32 s33, 15
    s_cselect_b32 s34, 1, 0
    s_sub_u32 s35, s29, 10
    s_cmp_lt_u32 s35, 20
    s_cbranch_scc0 K_MAPD
    s_and_b32 s32, s32, 12
    s_and_b32 s36, s35, 3
    s_add_u32 s32, s32, s36
    s_lshr_b32 s33, s35, 2
    s_and_b32 s36, s28, 1
    s_mul_i32 s36, s36, 5
    s_add_u32 s33, s33, s36
    s_add_u32 s33, s33, 5
K_MAPD:
    v_lshrrev_b32 v1, 6, v0
    v_and_b32 v0, 63, v0
    v_readfirstlane_b32 s30, v1
    v_mov_b32 v1, 157888
    v_mov_b32 v2, 1
    s_and_b32 s3, s30, 3
    v_lshrrev_b32 v7, 3, v0
    v_lshrrev_b32 v8, 4, v0
    v_and_b32 v9, 7, v0
    v_xor_b32 v9, v9, v8
    s_lshl_b32 s36, s32, 7
    s_lshl_b32 s37, s3, 5
    s_add_u32 s36, s36, s37
    v_lshl_add_u32 v7, v7, 1, s36
    v_mul_u32_u24 v7, 1280, v7
    v_lshl_add_u32 v4, v9, 4, v7
    v_xor_b32 v5, 64, v4
    v_and_b32 v9, 15, v0
    v_lshlrev_b32 v6, 1, v8
    v_xor_b32 v9, v9, v6
    s_lshl_b32 s37, s3, 4
    v_add_u32 v8, s37, v8
    v_mul_u32_u24 v8, 3840, v8
    v_lshl_add_u32 v6, v9, 4, v8
    s_lshl_b32 s37, s33, 8
    v_add_u32 v6, s37, v6
    v_xor_b32 v128, 128, v6
    s_lshl_b32 s39, s3, 12
    s_mul_i32 s40, s32, 5
    s_add_u32 s40, s40, s33
    s_mul_i32 s41, s40, 205
    s_lshr_b32 s41, s41, 11
    s_mul_i32 s41, s41, 10
    s_sub_u32 s40, s40, s41
    s_waitcnt lgkmcnt(0)
    s_mov_b32 s52, s4
    s_mov_b32 s53, s5
    s_mov_b32 s54, 2621440
    s_mov_b32 s55, 0x20000
    s_mov_b32 s48, s26
    s_mov_b32 s49, s27
    s_mov_b32 s50, 9404416
    s_mov_b32 s51, 0x20000
    s_cmp_lt_u32 s30, 4
    s_cbranch_scc1 R_C
    s_cmp_lt_u32 s30, 8
    s_cbranch_scc1 R_M
    s_cmp_eq_u32 s34, 1
    s_cbranch_scc1 R_MOE
    s_mov_b32 s56, s6
    s_mov_b32 s57, s7
    s_mov_b32 s58, 2457600
    s_mov_b32 s59, 0x20000
    s_lshl_b32 s42, s40, 7
    s_mul_i32 s43, s40, 245760
    s_add_u32 s40, s40, 1
    s_cmp_eq_u32 s40, 10
    s_cselect_b32 s40, 0, s40
    s_add_u32 m0, s39, 0
    s_nop 0
    buffer_load_dwordx4 v4, s[52:55], s42 offen lds
    s_add_u32 m0, s39, 16384
    s_nop 0
    buffer_load_dwordx4 v6, s[56:59], s43 offen lds
    s_add_u32 m0, s39, 1024
    s_add_u32 s42, s42, 20480
    buffer_load_dwordx4 v5, s[52:55], s42 offen lds
    s_add_u32 m0, s39, 17408
    s_add_u32 s43, s43, 15360
    buffer_load_dwordx4 v6, s[56:59], s43 offen lds
    s_add_u32 m0, s39, 2048
    s_sub_u32 s42, s42, 19200
    buffer_load_dwordx4 v4, s[52:55], s42 offen lds
    s_add_u32 m0, s39, 18432
    s_add_u32 s43, s43, 15360
    buffer_load_dwordx4 v128, s[56:59], s43 offen lds
    s_add_u32 m0, s39, 3072
    s_add_u32 s42, s42, 20480
    buffer_load_dwordx4 v5, s[52:55], s42 offen lds
    s_add_u32 m0, s39, 19456
    s_add_u32 s43, s43, 15360
    buffer_load_dwordx4 v128, s[56:59], s43 offen lds
    s_lshl_b32 s42, s40, 7
    s_mul_i32 s43, s40, 245760
    s_add_u32 s40, s40, 1
    s_cmp_eq_u32 s40, 10
    s_cselect_b32 s40, 0, s40
    s_add_u32 m0, s39, 32768
    s_nop 0
    buffer_load_dwordx4 v4, s[52:55], s42 offen lds
    s_add_u32 m0, s39, 49152
    s_nop 0
    buffer_load_dwordx4 v6, s[56:59], s43 offen lds
    s_add_u32 m0, s39, 33792
    s_add_u32 s42, s42, 20480
    buffer_load_dwordx4 v5, s[52:55], s42 offen lds
    s_add_u32 m0, s39, 50176
    s_add_u32 s43, s43, 15360
    buffer_load_dwordx4 v6, s[56:59], s43 offen lds
    s_add_u32 m0, s39, 34816
    s_sub_u32 s42, s42, 19200
    buffer_load_dwordx4 v4, s[52:55], s42 offen lds
    s_add_u32 m0, s39, 51200
    s_add_u32 s43, s43, 15360
    buffer_load_dwordx4 v128, s[56:59], s43 offen lds
    s_add_u32 m0, s39, 35840
    s_add_u32 s42, s42, 20480
    buffer_load_dwordx4 v5, s[52:55], s42 offen lds
    s_add_u32 m0, s39, 52224
    s_add_u32 s43, s43, 15360
    buffer_load_dwordx4 v128, s[56:59], s43 offen lds
    s_waitcnt vmcnt(8)
    s_barrier
    s_lshl_b32 s42, s40, 7
    s_mul_i32 s43, s40, 245760
    s_add_u32 s40, s40, 1
    s_cmp_eq_u32 s40, 10
    s_cselect_b32 s40, 0, s40
    s_add_u32 m0, s39, 65536
    s_nop 0
    buffer_load_dwordx4 v4, s[52:55], s42 offen lds
    s_add_u32 m0, s39, 81920
    s_nop 0
    buffer_load_dwordx4 v6, s[56:59], s43 offen lds
    s_add_u32 m0, s39, 66560
    s_add_u32 s42, s42, 20480
    buffer_load_dwordx4 v5, s[52:55], s42 offen lds
    s_add_u32 m0, s39, 82944
    s_add_u32 s43, s43, 15360
    buffer_load_dwordx4 v6, s[56:59], s43 offen lds
    s_add_u32 m0, s39, 67584
    s_sub_u32 s42, s42, 19200
    buffer_load_dwordx4 v4, s[52:55], s42 offen lds
    s_add_u32 m0, s39, 83968
    s_add_u32 s43, s43, 15360
    buffer_load_dwordx4 v128, s[56:59], s43 offen lds
    s_add_u32 m0, s39, 68608
    s_add_u32 s42, s42, 20480
    buffer_load_dwordx4 v5, s[52:55], s42 offen lds
    s_add_u32 m0, s39, 84992
    s_add_u32 s43, s43, 15360
    buffer_load_dwordx4 v128, s[56:59], s43 offen lds
    s_lshl_b32 s42, s40, 7
    s_mul_i32 s43, s40, 245760
    s_add_u32 s40, s40, 1
    s_cmp_eq_u32 s40, 10
    s_cselect_b32 s40, 0, s40
    s_add_u32 m0, s39, 98304
    s_nop 0
    buffer_load_dwordx4 v4, s[52:55], s42 offen lds
    s_add_u32 m0, s39, 114688
    s_nop 0
    buffer_load_dwordx4 v6, s[56:59], s43 offen lds
    s_add_u32 m0, s39, 99328
    s_add_u32 s42, s42, 20480
    buffer_load_dwordx4 v5, s[52:55], s42 offen lds
    s_add_u32 m0, s39, 115712
    s_add_u32 s43, s43, 15360
    buffer_load_dwordx4 v6, s[56:59], s43 offen lds
    s_add_u32 m0, s39, 100352
    s_sub_u32 s42, s42, 19200
    buffer_load_dwordx4 v4, s[52:55], s42 offen lds
    s_add_u32 m0, s39, 116736
    s_add_u32 s43, s43, 15360
    buffer_load_dwordx4 v128, s[56:59], s43 offen lds
    s_add_u32 m0, s39, 101376
    s_add_u32 s42, s42, 20480
    buffer_load_dwordx4 v5, s[52:55], s42 offen lds
    s_add_u32 m0, s39, 117760
    s_add_u32 s43, s43, 15360
    buffer_load_dwordx4 v128, s[56:59], s43 offen lds
    ds_read_b32 v8, v1 offset:128
    s_waitcnt lgkmcnt(0)
    v_readfirstlane_b32 s31, v8
    s_waitcnt vmcnt(16)
    s_barrier
    s_lshl_b32 s42, s40, 7
    s_mul_i32 s43, s40, 245760
    s_add_u32 s40, s40, 1
    s_cmp_eq_u32 s40, 10
    s_cselect_b32 s40, 0, s40
    s_add_u32 m0, s39, 0
    s_nop 0
    buffer_load_dwordx4 v4, s[52:55], s42 offen lds
    s_add_u32 m0, s39, 16384
    s_nop 0
    buffer_load_dwordx4 v6, s[56:59], s43 offen lds
    s_add_u32 m0, s39, 1024
    s_add_u32 s42, s42, 20480
    buffer_load_dwordx4 v5, s[52:55], s42 offen lds
    s_add_u32 m0, s39, 17408
    s_add_u32 s43, s43, 15360
    buffer_load_dwordx4 v6, s[56:59], s43 offen lds
    s_add_u32 m0, s39, 2048
    s_sub_u32 s42, s42, 19200
    buffer_load_dwordx4 v4, s[52:55], s42 offen lds
    s_add_u32 m0, s39, 18432
    s_add_u32 s43, s43, 15360
    buffer_load_dwordx4 v128, s[56:59], s43 offen lds
    s_add_u32 m0, s39, 3072
    s_add_u32 s42, s42, 20480
    buffer_load_dwordx4 v5, s[52:55], s42 offen lds
    s_add_u32 m0, s39, 19456
    s_add_u32 s43, s43, 15360
    buffer_load_dwordx4 v128, s[56:59], s43 offen lds
    s_waitcnt vmcnt(16)
    s_barrier
    s_lshl_b32 s42, s40, 7
    s_mul_i32 s43, s40, 245760
    s_add_u32 s40, s40, 1
    s_cmp_eq_u32 s40, 10
    s_cselect_b32 s40, 0, s40
    s_add_u32 m0, s39, 32768
    s_nop 0
    buffer_load_dwordx4 v4, s[52:55], s42 offen lds
    s_add_u32 m0, s39, 49152
    s_nop 0
    buffer_load_dwordx4 v6, s[56:59], s43 offen lds
    s_add_u32 m0, s39, 33792
    s_add_u32 s42, s42, 20480
    buffer_load_dwordx4 v5, s[52:55], s42 offen lds
    s_add_u32 m0, s39, 50176
    s_add_u32 s43, s43, 15360
    buffer_load_dwordx4 v6, s[56:59], s43 offen lds
    s_add_u32 m0, s39, 34816
    s_sub_u32 s42, s42, 19200
    buffer_load_dwordx4 v4, s[52:55], s42 offen lds
    s_add_u32 m0, s39, 51200
    s_add_u32 s43, s43, 15360
    buffer_load_dwordx4 v128, s[56:59], s43 offen lds
    s_add_u32 m0, s39, 35840
    s_add_u32 s42, s42, 20480
    buffer_load_dwordx4 v5, s[52:55], s42 offen lds
    s_add_u32 m0, s39, 52224
    s_add_u32 s43, s43, 15360
    buffer_load_dwordx4 v128, s[56:59], s43 offen lds
    s_waitcnt vmcnt(16)
    s_barrier
    s_lshl_b32 s42, s40, 7
    s_mul_i32 s43, s40, 245760
    s_add_u32 s40, s40, 1
    s_cmp_eq_u32 s40, 10
    s_cselect_b32 s40, 0, s40
    s_add_u32 m0, s39, 65536
    s_nop 0
    buffer_load_dwordx4 v4, s[52:55], s42 offen lds
    s_add_u32 m0, s39, 81920
    s_nop 0
    buffer_load_dwordx4 v6, s[56:59], s43 offen lds
    s_add_u32 m0, s39, 66560
    s_add_u32 s42, s42, 20480
    buffer_load_dwordx4 v5, s[52:55], s42 offen lds
    s_add_u32 m0, s39, 82944
    s_add_u32 s43, s43, 15360
    buffer_load_dwordx4 v6, s[56:59], s43 offen lds
    s_add_u32 m0, s39, 67584
    s_sub_u32 s42, s42, 19200
    buffer_load_dwordx4 v4, s[52:55], s42 offen lds
    s_add_u32 m0, s39, 83968
    s_add_u32 s43, s43, 15360
    buffer_load_dwordx4 v128, s[56:59], s43 offen lds
    s_add_u32 m0, s39, 68608
    s_add_u32 s42, s42, 20480
    buffer_load_dwordx4 v5, s[52:55], s42 offen lds
    s_add_u32 m0, s39, 84992
    s_add_u32 s43, s43, 15360
    buffer_load_dwordx4 v128, s[56:59], s43 offen lds
    s_mov_b32 s66, s29
    s_cmp_eq_u32 s3, 0
    s_cselect_b32 s67, 1, 0
    s_cmp_lt_u32 s66, 15
    s_cselect_b32 s60, s14, s16
    s_cselect_b32 s61, s15, s17
    s_cselect_b32 s37, 0, 15
    s_cselect_b32 s64, 0, 5
    s_sub_u32 s44, s66, s37
    s_mul_i32 s45, s44, 11
    s_lshr_b32 s45, s45, 5
    s_mul_i32 s36, s45, 3
    s_sub_u32 s44, s44, s36
    s_mov_b32 s62, 1966080
    s_mov_b32 s63, 0x20000
    v_and_b32 v11, 7, v0
    v_lshrrev_b32 v12, 4, v0
    v_bfe_u32 v8, v0, 3, 1
    v_lshl_add_u32 v13, v8, 2, v12
    s_lshl_b32 s36, s45, 7
    v_lshl_add_u32 v13, v13, 3, s36
    v_mul_u32_u24 v7, 3072, v13
    v_lshl_add_u32 v7, v11, 4, v7
    s_mul_i32 s36, s28, 3
    s_add_u32 s36, s36, s44
    s_lshl_b32 s36, s36, 7
    v_add_u32 v7, s36, v7
    v_lshrrev_b32 v129, 5, v0
    v_mul_u32_u24 v129, 3072, v129
    v_lshl_add_u32 v129, v11, 5, v129
    v_and_b32 v12, 1, v12
    v_lshl_add_u32 v129, v12, 4, v129
    s_add_u32 s64, s64, s45
    s_mul_i32 s37, s28, 10
    s_add_u32 s64, s64, s37
    s_mul_i32 s64, s64, 6144
    s_lshl_b32 s37, s44, 8
    s_add_u32 s64, s64, s37
    s_add_u32 s64, s64, 8912896
    s_lshl_b32 s65, s28, 5
    s_add_u32 s65, s65, s66
    s_lshl_b32 s65, s65, 2
    s_add_u32 s65, s65, 8847360
    v_lshrrev_b32 v9, 3, v0
    v_mul_u32_u24 v9, 16640, v9
    v_lshl_add_u32 v9, v11, 7, v9
    s_lshl_b32 s36, s33, 2
    s_add_u32 s36, s36, s3
    s_mul_i32 s36, s36, 133120
    s_lshl_b32 s37, s32, 10
    s_add_u32 s36, s36, s37
    s_cmp_lt_u32 s29, 10
    s_cselect_b32 s36, s36, 0x40000000
    v_add_u32 v9, s36, v9
    s_waitcnt vmcnt(16)
    s_barrier
    s_lshl_b32 s42, s40, 7
    s_mul_i32 s43, s40, 245760
    s_add_u32 s40, s40, 1
    s_cmp_eq_u32 s40, 10
    s_cselect_b32 s40, 0, s40
    s_add_u32 m0, s39, 98304
    s_nop 0
    buffer_load_dwordx4 v4, s[52:55], s42 offen lds
    s_add_u32 m0, s39, 114688
    s_nop 0
    buffer_load_dwordx4 v6, s[56:59], s43 offen lds
    s_add_u32 m0, s39, 99328
    s_add_u32 s42, s42, 20480
    buffer_load_dwordx4 v5, s[52:55], s42 offen lds
    s_add_u32 m0, s39, 115712
    s_add_u32 s43, s43, 15360
    buffer_load_dwordx4 v6, s[56:59], s43 offen lds
    s_add_u32 m0, s39, 100352
    s_sub_u32 s42, s42, 19200
    buffer_load_dwordx4 v4, s[52:55], s42 offen lds
    s_add_u32 m0, s39, 116736
    s_add_u32 s43, s43, 15360
    buffer_load_dwordx4 v128, s[56:59], s43 offen lds
    s_add_u32 m0, s39, 101376
    s_add_u32 s42, s42, 20480
    buffer_load_dwordx4 v5, s[52:55], s42 offen lds
    s_add_u32 m0, s39, 117760
    s_add_u32 s43, s43, 15360
    buffer_load_dwordx4 v128, s[56:59], s43 offen lds
    s_waitcnt vmcnt(16)
    s_barrier
    buffer_load_dword v130, v9, s[48:51], 0 offen
    s_lshl_b32 s42, s40, 7
    s_mul_i32 s43, s40, 245760
    s_add_u32 s40, s40, 1
    s_cmp_eq_u32 s40, 10
    s_cselect_b32 s40, 0, s40
    s_add_u32 m0, s39, 0
    s_nop 0
    buffer_load_dwordx4 v4, s[52:55], s42 offen lds
    s_add_u32 m0, s39, 16384
    s_nop 0
    buffer_load_dwordx4 v6, s[56:59], s43 offen lds
    s_add_u32 m0, s39, 1024
    s_add_u32 s42, s42, 20480
    buffer_load_dwordx4 v5, s[52:55], s42 offen lds
    s_add_u32 m0, s39, 17408
    s_add_u32 s43, s43, 15360
    buffer_load_dwordx4 v6, s[56:59], s43 offen lds
    s_add_u32 m0, s39, 2048
    s_sub_u32 s42, s42, 19200
    buffer_load_dwordx4 v4, s[52:55], s42 offen lds
    s_add_u32 m0, s39, 18432
    s_add_u32 s43, s43, 15360
    buffer_load_dwordx4 v128, s[56:59], s43 offen lds
    s_add_u32 m0, s39, 3072
    s_add_u32 s42, s42, 20480
    buffer_load_dwordx4 v5, s[52:55], s42 offen lds
    s_add_u32 m0, s39, 19456
    s_add_u32 s43, s43, 15360
    buffer_load_dwordx4 v128, s[56:59], s43 offen lds
    s_waitcnt vmcnt(17)
    s_barrier
    s_lshl_b32 s42, s40, 7
    s_mul_i32 s43, s40, 245760
    s_add_u32 s40, s40, 1
    s_cmp_eq_u32 s40, 10
    s_cselect_b32 s40, 0, s40
    s_add_u32 m0, s39, 32768
    s_nop 0
    buffer_load_dwordx4 v4, s[52:55], s42 offen lds
    s_add_u32 m0, s39, 49152
    s_nop 0
    buffer_load_dwordx4 v6, s[56:59], s43 offen lds
    s_add_u32 m0, s39, 33792
    s_add_u32 s42, s42, 20480
    buffer_load_dwordx4 v5, s[52:55], s42 offen lds
    s_add_u32 m0, s39, 50176
    s_add_u32 s43, s43, 15360
    buffer_load_dwordx4 v6, s[56:59], s43 offen lds
    s_add_u32 m0, s39, 34816
    s_sub_u32 s42, s42, 19200
    buffer_load_dwordx4 v4, s[52:55], s42 offen lds
    s_add_u32 m0, s39, 51200
    s_add_u32 s43, s43, 15360
    buffer_load_dwordx4 v128, s[56:59], s43 offen lds
    s_add_u32 m0, s39, 35840
    s_add_u32 s42, s42, 20480
    buffer_load_dwordx4 v5, s[52:55], s42 offen lds
    s_add_u32 m0, s39, 52224
    s_add_u32 s43, s43, 15360
    buffer_load_dwordx4 v128, s[56:59], s43 offen lds
    s_waitcnt vmcnt(17)
    s_barrier
    s_waitcnt vmcnt(8)
    s_barrier
    s_cmp_eq_u32 s67, 1
    s_cbranch_scc1 A_TA
    s_waitcnt vmcnt(0)
    s_barrier
    s_branch A_NOA
A_TA:
    v_lshlrev_b32 v9, 3, v11
    s_mov_b32 s37, 8402944
    buffer_load_dwordx2 v[14:15], v9, s[48:51], s37 offen sc1
    s_mov_b32 s36, 0
    buffer_load_dwordx4 v[16:19], v7, s[60:63], s36 offen offset:0
    buffer_load_dwordx4 v[20:23], v7, s[60:63], s36 offen offset:3072
    s_mov_b32 s36, 6144
    buffer_load_dwordx4 v[24:27], v7, s[60:63], s36 offen offset:0
    buffer_load_dwordx4 v[28:31], v7, s[60:63], s36 offen offset:3072
    s_mov_b32 s36, 12288
    buffer_load_dwordx4 v[32:35], v7, s[60:63], s36 offen offset:0
    buffer_load_dwordx4 v[36:39], v7, s[60:63], s36 offen offset:3072
    s_mov_b32 s36, 18432
    buffer_load_dwordx4 v[40:43], v7, s[60:63], s36 offen offset:0
    buffer_load_dwordx4 v[44:47], v7, s[60:63], s36 offen offset:3072
    s_mov_b32 s36, 196608
    buffer_load_dwordx4 v[48:51], v7, s[60:63], s36 offen offset:0
    buffer_load_dwordx4 v[52:55], v7, s[60:63], s36 offen offset:3072
    s_mov_b32 s36, 202752
    buffer_load_dwordx4 v[56:59], v7, s[60:63], s36 offen offset:0
    buffer_load_dwordx4 v[60:63], v7, s[60:63], s36 offen offset:3072
    s_mov_b32 s36, 208896
    buffer_load_dwordx4 v[64:67], v7, s[60:63], s36 offen offset:0
    buffer_load_dwordx4 v[68:71], v7, s[60:63], s36 offen offset:3072
    s_mov_b32 s36, 215040
    buffer_load_dwordx4 v[72:75], v7, s[60:63], s36 offen offset:0
    buffer_load_dwordx4 v[76:79], v7, s[60:63], s36 offen offset:3072
    s_waitcnt vmcnt(17)
    s_barrier
    s_waitcnt vmcnt(16)
    v_cmp_ne_u32 vcc, s31, v15
    s_cbranch_vccz A_SOK
    s_mov_b32 s46, 1048576
PF_1:
    buffer_load_dwordx2 v[14:15], v9, s[48:51], s37 offen sc1
    s_sub_u32 s46, s46, 1
    s_cbranch_scc1 PF_2
    s_waitcnt vmcnt(0)
    v_cmp_ne_u32 vcc, s31, v15
    s_cbranch_vccz PF_2
    s_sleep 2
    s_branch PF_1
PF_2:
    s_waitcnt vmcnt(0)
A_SOK:
    v_and_b32 v14, 0xffff, v14
    v_sub_u32 v14, 0xffff, v14
    v_mul_u32_u24 v14, 1280, v14
    v_lshl_add_u32 v14, v13, 1, v14
    buffer_load_dwordx4 v[80:83], v14, s[52:55], 0 offen
    buffer_load_dwordx4 v[84:87], v14, s[52:55], 0 offen offset:128
    s_mov_b32 s38, 0x05040100
    s_mov_b32 s39, 0x07060302
    s_setprio 2
    s_mov_b32 s46, 16777216
LW_3:
    ds_read_b32 v9, v1 offset:32
    s_sub_u32 s46, s46, 1
    s_cbranch_scc1 LW_4
    s_waitcnt lgkmcnt(0)
    v_readfirstlane_b32 s42, v9
    s_nop 0
    s_cmp_ge_u32 s42, 1
    s_cbranch_scc1 LW_4
    s_sleep 1
    s_branch LW_3
LW_4:
    s_waitcnt vmcnt(0)
    v_perm_b32 v88, v20, v16, s38
    v_perm_b32 v89, v28, v24, s38
    v_perm_b32 v90, v36, v32, s38
    v_perm_b32 v91, v44, v40, s38
    v_perm_b32 v92, v20, v16, s39
    v_perm_b32 v93, v28, v24, s39
    v_perm_b32 v94, v36, v32, s39
    v_perm_b32 v95, v44, v40, s39
    v_mfma_f32_16x16x32_bf16 v[96:99], v[80:83], v[88:91], 0
    v_perm_b32 v88, v21, v17, s38
    v_perm_b32 v89, v29, v25, s38
    v_perm_b32 v90, v37, v33, s38
    v_perm_b32 v91, v45, v41, s38
    v_mfma_f32_16x16x32_bf16 v[100:103], v[80:83], v[92:95], 0
    v_perm_b32 v92, v21, v17, s39
    v_perm_b32 v93, v29, v25, s39
    v_perm_b32 v94, v37, v33, s39
    v_perm_b32 v95, v45, v41, s39
    v_mfma_f32_16x16x32_bf16 v[104:107], v[80:83], v[88:91], 0
    v_perm_b32 v88, v22, v18, s38
    v_perm_b32 v89, v30, v26, s38
    v_perm_b32 v90, v38, v34, s38
    v_perm_b32 v91, v46, v42, s38
    v_mfma_f32_16x16x32_bf16 v[108:111], v[80:83], v[92:95], 0
    v_perm_b32 v92, v22, v18, s39
    v_perm_b32 v93, v30, v26, s39
    v_perm_b32 v94, v38, v34, s39
    v_perm_b32 v95, v46, v42, s39
    v_mfma_f32_16x16x32_bf16 v[112:115], v[80:83], v[88:91], 0
    v_perm_b32 v88, v23, v19, s38
    v_perm_b32 v89, v31, v27, s38
    v_perm_b32 v90, v39, v35, s38
    v_perm_b32 v91, v47, v43, s38
    v_mfma_f32_16x16x32_bf16 v[116:119], v[80:83], v[92:95], 0
    v_perm_b32 v92, v23, v19, s39
    v_perm_b32 v93, v31, v27, s39
    v_perm_b32 v94, v39, v35, s39
    v_perm_b32 v95, v47, v43, s39
    v_mfma_f32_16x16x32_bf16 v[120:123], v[80:83], v[88:91], 0
    s_nop 0
    v_mfma_f32_16x16x32_bf16 v[124:127], v[80:83], v[92:95], 0
    v_perm_b32 v88, v52, v48, s38
    v_perm_b32 v89, v60, v56, s38
    v_perm_b32 v90, v68, v64, s38
    v_perm_b32 v91, v76, v72, s38
    v_perm_b32 v92, v52, v48, s39
    v_perm_b32 v93, v60, v56, s39
    v_perm_b32 v94, v68, v64, s39
    v_perm_b32 v95, v76, v72, s39
    v_mfma_f32_16x16x32_bf16 v[96:99], v[84:87], v[88:91], v[96:99]
    v_perm_b32 v88, v53, v49, s38
    v_perm_b32 v89, v61, v57, s38
    v_perm_b32 v90, v69, v65, s38
    v_perm_b32 v91, v77, v73, s38
    v_mfma_f32_16x16x32_bf16 v[100:103], v[84:87], v[92:95], v[100:103]
    v_perm_b32 v92, v53, v49, s39
    v_perm_b32 v93, v61, v57, s39
    v_perm_b32 v94, v69, v65, s39
    v_perm_b32 v95, v77, v73, s39
    v_mfma_f32_16x16x32_bf16 v[104:107], v[84:87], v[88:91], v[104:107]
    v_perm_b32 v88, v54, v50, s38
    v_perm_b32 v89, v62, v58, s38
    v_perm_b32 v90, v70, v66, s38
    v_perm_b32 v91, v78, v74, s38
    v_mfma_f32_16x16x32_bf16 v[108:111], v[84:87], v[92:95], v[108:111]
    v_perm_b32 v92, v54, v50, s39
    v_perm_b32 v93, v62, v58, s39
    v_perm_b32 v94, v70, v66, s39
    v_perm_b32 v95, v78, v74, s39
    v_mfma_f32_16x16x32_bf16 v[112:115], v[84:87], v[88:91], v[112:115]
    v_perm_b32 v88, v55, v51, s38
    v_perm_b32 v89, v63, v59, s38
    v_perm_b32 v90, v71, v67, s38
    v_perm_b32 v91, v79, v75, s38
    v_mfma_f32_16x16x32_bf16 v[116:119], v[84:87], v[92:95], v[116:119]
    v_perm_b32 v92, v55, v51, s39
    v_perm_b32 v93, v63, v59, s39
    v_perm_b32 v94, v71, v67, s39
    v_perm_b32 v95, v79, v75, s39
    v_mfma_f32_16x16x32_bf16 v[120:123], v[84:87], v[88:91], v[120:123]
    s_nop 0
    v_mfma_f32_16x16x32_bf16 v[124:127], v[84:87], v[92:95], v[124:127]
    v_permlane32_swap_b32 v96, v112
    v_permlane32_swap_b32 v97, v113
    v_permlane32_swap_b32 v98, v114
    v_permlane32_swap_b32 v99, v115
    v_permlane32_swap_b32 v100, v116
    v_permlane32_swap_b32 v101, v117
    v_permlane32_swap_b32 v102, v118
    v_permlane32_swap_b32 v103, v119
    v_permlane32_swap_b32 v104, v120
    v_permlane32_swap_b32 v105, v121
    v_permlane32_swap_b32 v106, v122
    v_permlane32_swap_b32 v107, v123
    v_permlane32_swap_b32 v108, v124
    v_permlane32_swap_b32 v109, v125
    v_permlane32_swap_b32 v110, v126
    v_permlane32_swap_b32 v111, v127
    v_add_f32_dpp v96, v112, v96 row_ror:8 row_mask:0xf bank_mask:0xf
    v_add_f32_dpp v97, v113, v97 row_ror:8 row_mask:0xf bank_mask:0xf
    v_add_f32_dpp v98, v114, v98 row_ror:8 row_mask:0xf bank_mask:0xf
    v_add_f32_dpp v99, v115, v99 row_ror:8 row_mask:0xf bank_mask:0xf
    v_add_f32_dpp v100, v116, v100 row_ror:8 row_mask:0xf bank_mask:0xf
    v_add_f32_dpp v101, v117, v101 row_ror:8 row_mask:0xf bank_mask:0xf
    v_add_f32_dpp v102, v118, v102 row_ror:8 row_mask:0xf bank_mask:0xf
    v_add_f32_dpp v103, v119, v103 row_ror:8 row_mask:0xf bank_mask:0xf
    v_add_f32_dpp v104, v120, v104 row_ror:8 row_mask:0xf bank_mask:0xf
    v_add_f32_dpp v105, v121, v105 row_ror:8 row_mask:0xf bank_mask:0xf
    v_add_f32_dpp v106, v122, v106 row_ror:8 row_mask:0xf bank_mask:0xf
    v_add_f32_dpp v107, v123, v107 row_ror:8 row_mask:0xf bank_mask:0xf
    v_add_f32_dpp v108, v124, v108 row_ror:8 row_mask:0xf bank_mask:0xf
    v_add_f32_dpp v109, v125, v109 row_ror:8 row_mask:0xf bank_mask:0xf
    v_add_f32_dpp v110, v126, v110 row_ror:8 row_mask:0xf bank_mask:0xf
    v_add_f32_dpp v111, v127, v111 row_ror:8 row_mask:0xf bank_mask:0xf
    s_mov_b32 exec_lo, 0x00ff00ff
    s_mov_b32 exec_hi, 0x00ff00ff
    s_cmp_eq_u32 s42, 1
    s_cbranch_scc1 A_SP
    buffer_store_dwordx4 v[96:99], v129, s[48:51], s64 offen offset:0 sc1
    buffer_store_dwordx4 v[100:103], v129, s[48:51], s64 offen offset:768 sc1
    buffer_store_dwordx4 v[104:107], v129, s[48:51], s64 offen offset:1536 sc1
    buffer_store_dwordx4 v[108:111], v129, s[48:51], s64 offen offset:2304 sc1
    s_branch A_SD
A_SP:
    buffer_store_dwordx4 v[96:99], v129, s[48:51], s64 offen offset:0
    buffer_store_dwordx4 v[100:103], v129, s[48:51], s64 offen offset:768
    buffer_store_dwordx4 v[104:107], v129, s[48:51], s64 offen offset:1536
    buffer_store_dwordx4 v[108:111], v129, s[48:51], s64 offen offset:2304
A_SD:
    s_mov_b64 exec, -1
    s_waitcnt vmcnt(0)
    v_mov_b32 v9, s31
    s_mov_b64 exec, 1
    s_cmp_eq_u32 s42, 1
    s_cbranch_scc1 FS_5
    buffer_store_dword v9, off, s[48:51], s65 sc1
    s_branch FS_6
FS_5:
    buffer_store_dword v9, off, s[48:51], s65
FS_6:
    s_mov_b64 exec, -1
    s_setprio 0
A_NOA:
    v_and_b32 v4, 7, v0
    v_lshlrev_b32 v4, 3, v4
    s_mov_b32 s36, 8402944
    s_mov_b32 s46, 1048576
PF_7:
    buffer_load_dwordx2 v[6:7], v4, s[48:51], s36 offen sc1
    s_sub_u32 s46, s46, 1
    s_cbranch_scc1 PF_8
    s_waitcnt vmcnt(0)
    v_cmp_ne_u32 vcc, s31, v7
    s_cbranch_vccz PF_8
    s_sleep 3
    s_branch PF_7
PF_8:
    s_waitcnt vmcnt(0)
    s_lshl_b32 s38, s28, 2
    s_and_b32 s39, s29, 3
    s_add_u32 s38, s38, s39
    s_lshl_b32 s38, s38, 6
    v_add_u32 v5, s38, v0
    v_lshlrev_b32 v4, 2, v5
    s_mov_b32 s36, 8413184
    buffer_load_dword v10, v4, s[48:51], s36 offen sc1
    v_lshlrev_b32 v4, 3, v5
    s_mov_b32 s36, 8454144
    s_mov_b32 s46, 1048576
PF_9:
    buffer_load_dwordx2 v[8:9], v4, s[48:51], s36 offen sc1
    s_sub_u32 s46, s46, 1
    s_cbranch_scc1 PF_10
    s_waitcnt vmcnt(0)
    v_cmp_ne_u32 vcc, s31, v9
    s_cbranch_vccz PF_10
    s_sleep 3
    s_branch PF_9
PF_10:
    s_waitcnt vmcnt(0)
    v_lshlrev_b32 v8, 16, v8
    v_sub_u32 v5, 0xffff, v5
    v_mov_b32 v9, 0
    v_readlane_b32 s36, v6, 0
    s_nop 0
    s_and_b32 s36, s36, 0xffff
    v_mov_b32 v10, 320
    v_cmp_eq_u32 vcc, s36, v5
    s_nop 1
    v_cndmask_b32 v9, v9, v10, vcc
    v_readlane_b32 s36, v6, 1
    s_nop 0
    s_and_b32 s36, s36, 0xffff
    v_mov_b32 v10, 640
    v_cmp_eq_u32 vcc, s36, v5
    s_nop 1
    v_cndmask_b32 v9, v9, v10, vcc
    v_readlane_b32 s36, v6, 2
    s_nop 0
    s_and_b32 s36, s36, 0xffff
    v_mov_b32 v10, 960
    v_cmp_eq_u32 vcc, s36, v5
    s_nop 1
    v_cndmask_b32 v9, v9, v10, vcc
    v_readlane_b32 s36, v6, 3
    s_nop 0
    s_and_b32 s36, s36, 0xffff
    v_mov_b32 v10, 1280
    v_cmp_eq_u32 vcc, s36, v5
    s_nop 1
    v_cndmask_b32 v9, v9, v10, vcc
    v_readlane_b32 s36, v6, 4
    s_nop 0
    s_and_b32 s36, s36, 0xffff
    v_mov_b32 v10, 1600
    v_cmp_eq_u32 vcc, s36, v5
    s_nop 1
    v_cndmask_b32 v9, v9, v10, vcc
    v_readlane_b32 s36, v6, 5
    s_nop 0
    s_and_b32 s36, s36, 0xffff
    v_mov_b32 v10, 1920
    v_cmp_eq_u32 vcc, s36, v5
    s_nop 1
    v_cndmask_b32 v9, v9, v10, vcc
    v_readlane_b32 s36, v6, 6
    s_nop 0
    s_and_b32 s36, s36, 0xffff
    v_mov_b32 v10, 2240
    v_cmp_eq_u32 vcc, s36, v5
    s_nop 1
    v_cndmask_b32 v9, v9, v10, vcc
    v_readlane_b32 s36, v6, 7
    s_nop 0
    s_and_b32 s36, s36, 0xffff
    v_mov_b32 v10, 2560
    v_cmp_eq_u32 vcc, s36, v5
    s_nop 1
    v_cndmask_b32 v9, v9, v10, vcc
    v_lshl_add_u32 v4, v0, 3, v1
    ds_write_b64 v4, v[8:9] offset:288
    s_waitcnt lgkmcnt(0)
    s_mov_b32 s46, 16777216
LW_11:
    ds_read_b32 v9, v1 offset:80
    s_sub_u32 s46, s46, 1
    s_cbranch_scc1 LW_12
    s_waitcnt lgkmcnt(0)
    v_readfirstlane_b32 s47, v9
    s_nop 0
    s_cmp_ge_u32 s47, 8
    s_cbranch_scc1 LW_12
    s_sleep 2
    s_branch LW_11
LW_12:
    s_setprio 0
    s_mov_b32 s60, s8
    s_mov_b32 s61, s9
    s_mov_b32 s62, 819200
    s_mov_b32 s63, 0x20000
    v_mul_u32_u24 v4, 26, v0
    v_lshrrev_b32 v4, 8, v4
    v_mul_u32_u24 v5, 10, v4
    v_sub_u32 v5, v0, v5
    v_mul_u32_u24 v4, 1280, v4
    v_lshl_add_u32 v4, v5, 4, v4
    s_lshr_b32 s37, s29, 2
    s_mul_i32 s37, s37, 160
    v_add_u32 v4, s37, v4
    s_mul_i32 s36, s3, 51200
    s_mul_i32 s37, s3, 6400
    s_mov_b32 exec_hi, 0x3ffff
    s_add_u32 s39, s29, 0
    s_and_b32 s39, s39, 3
    s_mul_i32 s40, s39, 204800
    s_add_u32 s40, s40, s36
    s_mul_i32 s39, s39, 25600
    s_add_u32 s39, s39, s37
    s_add_u32 m0, s39, 45248
    s_add_u32 s38, s40, 0
    buffer_load_dwordx4 v4, s[60:63], s38 offen lds
    s_add_u32 m0, s39, 46048
    s_add_u32 s38, s40, 6400
    buffer_load_dwordx4 v4, s[60:63], s38 offen lds
    s_add_u32 m0, s39, 46848
    s_add_u32 s38, s40, 12800
    buffer_load_dwordx4 v4, s[60:63], s38 offen lds
    s_add_u32 m0, s39, 47648
    s_add_u32 s38, s40, 19200
    buffer_load_dwordx4 v4, s[60:63], s38 offen lds
    s_add_u32 m0, s39, 48448
    s_add_u32 s38, s40, 25600
    buffer_load_dwordx4 v4, s[60:63], s38 offen lds
    s_add_u32 m0, s39, 49248
    s_add_u32 s38, s40, 32000
    buffer_load_dwordx4 v4, s[60:63], s38 offen lds
    s_add_u32 m0, s39, 50048
    s_add_u32 s38, s40, 38400
    buffer_load_dwordx4 v4, s[60:63], s38 offen lds
    s_add_u32 m0, s39, 50848
    s_add_u32 s38, s40, 44800
    buffer_load_dwordx4 v4, s[60:63], s38 offen lds
    s_add_u32 s39, s29, 1
    s_and_b32 s39, s39, 3
    s_mul_i32 s40, s39, 204800
    s_add_u32 s40, s40, s36
    s_mul_i32 s39, s39, 25600
    s_add_u32 s39, s39, s37
    s_add_u32 m0, s39, 45248
    s_add_u32 s38, s40, 0
    buffer_load_dwordx4 v4, s[60:63], s38 offen lds
    s_add_u32 m0, s39, 46048
    s_add_u32 s38, s40, 6400
    buffer_load_dwordx4 v4, s[60:63], s38 offen lds
    s_add_u32 m0, s39, 46848
    s_add_u32 s38, s40, 12800
    buffer_load_dwordx4 v4, s[60:63], s38 offen lds
    s_add_u32 m0, s39, 47648
    s_add_u32 s38, s40, 19200
    buffer_load_dwordx4 v4, s[60:63], s38 offen lds
    s_add_u32 m0, s39, 48448
    s_add_u32 s38, s40, 25600
    buffer_load_dwordx4 v4, s[60:63], s38 offen lds
    s_add_u32 m0, s39, 49248
    s_add_u32 s38, s40, 32000
    buffer_load_dwordx4 v4, s[60:63], s38 offen lds
    s_add_u32 m0, s39, 50048
    s_add_u32 s38, s40, 38400
    buffer_load_dwordx4 v4, s[60:63], s38 offen lds
    s_add_u32 m0, s39, 50848
    s_add_u32 s38, s40, 44800
    buffer_load_dwordx4 v4, s[60:63], s38 offen lds
    s_add_u32 s39, s29, 2
    s_and_b32 s39, s39, 3
    s_mul_i32 s40, s39, 204800
    s_add_u32 s40, s40, s36
    s_mul_i32 s39, s39, 25600
    s_add_u32 s39, s39, s37
    s_add_u32 m0, s39, 45248
    s_add_u32 s38, s40, 0
    buffer_load_dwordx4 v4, s[60:63], s38 offen lds
    s_add_u32 m0, s39, 46048
    s_add_u32 s38, s40, 6400
    buffer_load_dwordx4 v4, s[60:63], s38 offen lds
    s_add_u32 m0, s39, 46848
    s_add_u32 s38, s40, 12800
    buffer_load_dwordx4 v4, s[60:63], s38 offen lds
    s_add_u32 m0, s39, 47648
    s_add_u32 s38, s40, 19200
    buffer_load_dwordx4 v4, s[60:63], s38 offen lds
    s_add_u32 m0, s39, 48448
    s_add_u32 s38, s40, 25600
    buffer_load_dwordx4 v4, s[60:63], s38 offen lds
    s_add_u32 m0, s39, 49248
    s_add_u32 s38, s40, 32000
    buffer_load_dwordx4 v4, s[60:63], s38 offen lds
    s_add_u32 m0, s39, 50048
    s_add_u32 s38, s40, 38400
    buffer_load_dwordx4 v4, s[60:63], s38 offen lds
    s_add_u32 m0, s39, 50848
    s_add_u32 s38, s40, 44800
    buffer_load_dwordx4 v4, s[60:63], s38 offen lds
    s_add_u32 s39, s29, 3
    s_and_b32 s39, s39, 3
    s_mul_i32 s40, s39, 204800
    s_add_u32 s40, s40, s36
    s_mul_i32 s39, s39, 25600
    s_add_u32 s39, s39, s37
    s_add_u32 m0, s39, 45248
    s_add_u32 s38, s40, 0
    buffer_load_dwordx4 v4, s[60:63], s38 offen lds
    s_add_u32 m0, s39, 46048
    s_add_u32 s38, s40, 6400
    buffer_load_dwordx4 v4, s[60:63], s38 offen lds
    s_add_u32 m0, s39, 46848
    s_add_u32 s38, s40, 12800
    buffer_load_dwordx4 v4, s[60:63], s38 offen lds
    s_add_u32 m0, s39, 47648
    s_add_u32 s38, s40, 19200
    buffer_load_dwordx4 v4, s[60:63], s38 offen lds
    s_add_u32 m0, s39, 48448
    s_add_u32 s38, s40, 25600
    buffer_load_dwordx4 v4, s[60:63], s38 offen lds
    s_add_u32 m0, s39, 49248
    s_add_u32 s38, s40, 32000
    buffer_load_dwordx4 v4, s[60:63], s38 offen lds
    s_add_u32 m0, s39, 50048
    s_add_u32 s38, s40, 38400
    buffer_load_dwordx4 v4, s[60:63], s38 offen lds
    s_add_u32 m0, s39, 50848
    s_add_u32 s38, s40, 44800
    buffer_load_dwordx4 v4, s[60:63], s38 offen lds
    s_lshl_b32 s36, s28, 2
    s_and_b32 s37, s29, 3
    s_add_u32 s36, s36, s37
    s_lshl_b32 s36, s36, 6
    s_lshl_b32 s37, s3, 4
    s_add_u32 s36, s36, s37
    s_mul_i32 s36, s36, 1280
    s_mul_i32 s37, s3, 2560
    s_mov_b32 exec_hi, 0xff
    s_add_u32 m0, s37, 147648
    s_add_u32 s38, s36, 0
    buffer_load_dwordx4 v4, s[52:55], s38 offen lds
    s_add_u32 m0, s37, 148288
    s_add_u32 s38, s36, 5120
    buffer_load_dwordx4 v4, s[52:55], s38 offen lds
    s_add_u32 m0, s37, 148928
    s_add_u32 s38, s36, 10240
    buffer_load_dwordx4 v4, s[52:55], s38 offen lds
    s_add_u32 m0, s37, 149568
    s_add_u32 s38, s36, 15360
    buffer_load_dwordx4 v4, s[52:55], s38 offen lds
    s_mov_b64 exec, -1
    s_waitcnt vmcnt(0)
    s_mov_b64 exec, 1
    ds_add_u32 v1, v2 offset:24
    s_mov_b64 exec, -1
A_YH:
    s_lshl_b32 s38, s28, 2
    s_and_b32 s39, s29, 3
    s_add_u32 s38, s38, s39
    s_lshl_b32 s38, s38, 6
    s_mov_b32 s40, s3
    s_lshr_b32 s36, s29, 2
    s_mul_i32 s36, s36, 80
    v_lshl_add_u32 v4, v0, 1, s36
    v_and_b32 v5, 0x383, v4
    v_bfe_u32 v7, v4, 3, 4
    v_lshl_add_u32 v5, v7, 2, v5
    v_bfe_u32 v7, v4, 2, 1
    v_lshl_add_u32 v5, v7, 6, v5
    v_cmp_gt_u32 vcc, 512, v4
    s_nop 1
    v_cndmask_b32 v11, v4, v5, vcc
    v_lshlrev_b32 v11, 2, v11
    v_lshl_add_u32 v4, v0, 3, v1
    v_lshlrev_b32 v5, 7, v0
    s_setprio 2
A_YLOOP:
    v_readlane_b32 s42, v6, s40
    s_nop 0
    s_andn2_b32 s43, 0xffff, s42
    s_sub_u32 s43, s43, s38
    s_cmp_ge_u32 s43, 64
    s_cbranch_scc1 A_YNEXT
    s_mov_b32 s36, 8404992
    s_mov_b64 exec, 0xffff
    s_mov_b32 s46, 1048576
PF_13:
    buffer_load_dword v12, v5, s[48:51], s36 offen sc1
    s_sub_u32 s46, s46, 1
    s_cbranch_scc1 PF_14
    s_waitcnt vmcnt(0)
    v_cmp_ne_u32 vcc, s31, v12
    s_cbranch_vccz PF_14
    s_sleep 2
    s_branch PF_13
PF_14:
    s_waitcnt vmcnt(0)
    s_mov_b32 exec_lo, -1
    s_mov_b32 exec_hi, 0xff
    s_mul_i32 s36, s40, 2560
    s_add_u32 s36, s36, 8519680
    buffer_load_dwordx2 v[16:17], v11, s[48:51], s36 offen sc1
    s_add_u32 s36, s36, 20480
    buffer_load_dwordx2 v[18:19], v11, s[48:51], s36 offen sc1
    s_add_u32 s36, s36, 20480
    buffer_load_dwordx2 v[20:21], v11, s[48:51], s36 offen sc1
    s_add_u32 s36, s36, 20480
    buffer_load_dwordx2 v[22:23], v11, s[48:51], s36 offen sc1
    s_add_u32 s36, s36, 20480
    buffer_load_dwordx2 v[24:25], v11, s[48:51], s36 offen sc1
    s_add_u32 s36, s36, 20480
    buffer_load_dwordx2 v[26:27], v11, s[48:51], s36 offen sc1
    s_add_u32 s36, s36, 20480
    buffer_load_dwordx2 v[28:29], v11, s[48:51], s36 offen sc1
    s_add_u32 s36, s36, 20480
    buffer_load_dwordx2 v[30:31], v11, s[48:51], s36 offen sc1
    s_add_u32 s36, s36, 20480
    buffer_load_dwordx2 v[32:33], v11, s[48:51], s36 offen sc1
    s_add_u32 s36, s36, 20480
    buffer_load_dwordx2 v[34:35], v11, s[48:51], s36 offen sc1
    s_add_u32 s36, s36, 20480
    buffer_load_dwordx2 v[36:37], v11, s[48:51], s36 offen sc1
    s_add_u32 s36, s36, 20480
    buffer_load_dwordx2 v[38:39], v11, s[48:51], s36 offen sc1
    s_add_u32 s36, s36, 20480
    buffer_load_dwordx2 v[40:41], v11, s[48:51], s36 offen sc1
    s_add_u32 s36, s36, 20480
    buffer_load_dwordx2 v[42:43], v11, s[48:51], s36 offen sc1
    s_add_u32 s36, s36, 20480
    buffer_load_dwordx2 v[44:45], v11, s[48:51], s36 offen sc1
    s_add_u32 s36, s36, 20480
    buffer_load_dwordx2 v[46:47], v11, s[48:51], s36 offen sc1
    s_ashr_i32 s37, s42, 31
    s_not_b32 s37, s37
    s_or_b32 s37, s37, 0x80000000
    s_xor_b32 s37, s37, s42
    s_and_b32 s37, s37, 0xffff0000
    v_mov_b32 v10, s37
    s_mov_b32 s37, 0xbfb8aa3b
    v_mul_f32 v10, s37, v10
    v_exp_f32 v10, v10
    s_nop 0
    v_add_f32 v10, 1.0, v10
    v_rcp_f32 v10, v10
    s_nop 0
    v_cvt_pk_bf16_f32 v10, v10, v10
    v_and_b32 v10, 0xffff0000, v10
    s_waitcnt vmcnt(0)
    v_pk_add_f32 v[16:17], v[16:17], v[32:33]
    v_pk_add_f32 v[18:19], v[18:19], v[34:35]
    v_pk_add_f32 v[20:21], v[20:21], v[36:37]
    v_pk_add_f32 v[22:23], v[22:23], v[38:39]
    v_pk_add_f32 v[24:25], v[24:25], v[40:41]
    v_pk_add_f32 v[26:27], v[26:27], v[42:43]
    v_pk_add_f32 v[28:29], v[28:29], v[44:45]
    v_pk_add_f32 v[30:31], v[30:31], v[46:47]
    v_pk_add_f32 v[16:17], v[16:17], v[24:25]
    v_pk_add_f32 v[18:19], v[18:19], v[26:27]
    v_pk_add_f32 v[20:21], v[20:21], v[28:29]
    v_pk_add_f32 v[22:23], v[22:23], v[30:31]
    v_pk_add_f32 v[16:17], v[16:17], v[20:21]
    v_pk_add_f32 v[18:19], v[18:19], v[22:23]
    v_pk_add_f32 v[16:17], v[16:17], v[18:19]
    v_cvt_pk_bf16_f32 v16, v16, v16
    v_and_b32 v16, 0xffff0000, v16
    v_cvt_pk_bf16_f32 v17, v17, v17
    v_and_b32 v17, 0xffff0000, v17
    v_mul_f32 v16, v16, v10
    v_mul_f32 v17, v17, v10
    v_cvt_pk_bf16_f32 v16, v16, v16
    v_and_b32 v16, 0xffff0000, v16
    v_cvt_pk_bf16_f32 v17, v17, v17
    v_and_b32 v17, 0xffff0000, v17
    s_mul_i32 s36, s40, 320
    v_add_u32 v8, s36, v4
    ds_write_b64 v8, v[16:17] offset:1120
    s_mov_b64 exec, -1
    s_waitcnt lgkmcnt(0)
A_YNEXT:
    s_add_u32 s40, s40, 4
    s_cmp_lt_u32 s40, 8
    s_cbranch_scc1 A_YLOOP
    s_lshl_b32 s36, s29, 2
    s_add_u32 s36, s36, s3
    s_cmp_lg_u32 s36, 3
    s_cbranch_scc1 A_NOWB
    v_lshlrev_b32 v4, 4, v0
    s_lshl_b32 s36, s28, 10
    s_add_u32 s36, s36, 8413184
    s_mov_b32 s46, 1048576
A_WBP:
    buffer_load_dwordx4 v[8:11], v4, s[48:51], s36 offen sc1
    s_sub_u32 s46, s46, 1
    s_cbranch_scc1 A_WBD
    s_waitcnt vmcnt(0)
    v_xor_b32 v8, s31, v8
    v_xor_b32 v9, s31, v9
    v_xor_b32 v10, s31, v10
    v_xor_b32 v11, s31, v11
    v_or3_b32 v8, v8, v9, v10
    v_or_b32 v8, v8, v11
    v_cmp_ne_u32 vcc, 0, v8
    s_cbranch_vccz A_WBD
    s_sleep 2
    s_branch A_WBP
A_WBD:
    buffer_wbl2 sc1
    s_barrier
    s_barrier
A_NOWB:
    s_endpgm
R_MOE:
    s_setprio 2
    s_mov_b32 s60, s18
    s_mov_b32 s61, s19
    s_mov_b32 s62, 1966080
    s_mov_b32 s63, 0x20000
    v_and_b32 v4, 15, v0
    v_lshrrev_b32 v5, 4, v0
    v_mul_u32_u24 v5, 10240, v5
    s_mul_i32 s36, s32, 122880
    v_add_u32 v5, s36, v5
    s_lshl_b32 s37, s3, 6
    v_lshl_add_u32 v6, v4, 2, s37
    v_lshl_add_u32 v4, v6, 2, v5
    v_add_u32 v5, v6, v5
    s_mov_b32 s38, 0x05040100
    s_mov_b32 s39, 0x07060302
    s_barrier
    s_cmp_lg_u32 s32, 0
    s_cbranch_scc1 M_L1
    s_barrier
    s_branch M_L1
    s_mov_b32 s46, 16777216
LW_15:
    ds_read_b32 v7, v1 offset:76
    s_sub_u32 s46, s46, 1
    s_cbranch_scc1 LW_16
    s_waitcnt lgkmcnt(0)
    v_readfirstlane_b32 s47, v7
    s_nop 0
    s_cmp_ge_u32 s47, 1
    s_cbranch_scc1 LW_16
    s_sleep 2
    s_branch LW_15
LW_16:
M_L1:
    s_mov_b32 s36, 81920
    buffer_load_dwordx4 v[88:91], v4, s[60:63], s36 offen offset:0
    buffer_load_dword v120, v5, s[60:63], s36 offen offset:1024
    buffer_load_dwordx4 v[92:95], v4, s[60:63], s36 offen offset:1280
    buffer_load_dword v121, v5, s[60:63], s36 offen offset:2304
    s_mov_b32 s36, 84480
    buffer_load_dwordx4 v[96:99], v4, s[60:63], s36 offen offset:0
    buffer_load_dword v122, v5, s[60:63], s36 offen offset:1024
    buffer_load_dwordx4 v[100:103], v4, s[60:63], s36 offen offset:1280
    buffer_load_dword v123, v5, s[60:63], s36 offen offset:2304
    s_mov_b32 s36, 87040
    buffer_load_dwordx4 v[104:107], v4, s[60:63], s36 offen offset:0
    buffer_load_dword v124, v5, s[60:63], s36 offen offset:1024
    buffer_load_dwordx4 v[108:111], v4, s[60:63], s36 offen offset:1280
    buffer_load_dword v125, v5, s[60:63], s36 offen offset:2304
    s_mov_b32 s36, 89600
    buffer_load_dwordx4 v[112:115], v4, s[60:63], s36 offen offset:0
    buffer_load_dword v126, v5, s[60:63], s36 offen offset:1024
    buffer_load_dwordx4 v[116:119], v4, s[60:63], s36 offen offset:1280
    buffer_load_dword v127, v5, s[60:63], s36 offen offset:2304
    s_mov_b32 s36, 40960
    buffer_load_dwordx4 v[48:51], v4, s[60:63], s36 offen offset:0
    buffer_load_dword v80, v5, s[60:63], s36 offen offset:1024
    buffer_load_dwordx4 v[52:55], v4, s[60:63], s36 offen offset:1280
    buffer_load_dword v81, v5, s[60:63], s36 offen offset:2304
    s_mov_b32 s36, 43520
    buffer_load_dwordx4 v[56:59], v4, s[60:63], s36 offen offset:0
    buffer_load_dword v82, v5, s[60:63], s36 offen offset:1024
    buffer_load_dwordx4 v[60:63], v4, s[60:63], s36 offen offset:1280
    buffer_load_dword v83, v5, s[60:63], s36 offen offset:2304
    s_mov_b32 s36, 46080
    buffer_load_dwordx4 v[64:67], v4, s[60:63], s36 offen offset:0
    buffer_load_dword v84, v5, s[60:63], s36 offen offset:1024
    buffer_load_dwordx4 v[68:71], v4, s[60:63], s36 offen offset:1280
    buffer_load_dword v85, v5, s[60:63], s36 offen offset:2304
    s_mov_b32 s36, 48640
    buffer_load_dwordx4 v[72:75], v4, s[60:63], s36 offen offset:0
    buffer_load_dword v86, v5, s[60:63], s36 offen offset:1024
    buffer_load_dwordx4 v[76:79], v4, s[60:63], s36 offen offset:1280
    buffer_load_dword v87, v5, s[60:63], s36 offen offset:2304
    s_mov_b32 s36, 0
    buffer_load_dwordx4 v[8:11], v4, s[60:63], s36 offen offset:0
    buffer_load_dword v40, v5, s[60:63], s36 offen offset:1024
    buffer_load_dwordx4 v[12:15], v4, s[60:63], s36 offen offset:1280
    buffer_load_dword v41, v5, s[60:63], s36 offen offset:2304
    s_mov_b32 s36, 2560
    buffer_load_dwordx4 v[16:19], v4, s[60:63], s36 offen offset:0
    buffer_load_dword v42, v5, s[60:63], s36 offen offset:1024
    buffer_load_dwordx4 v[20:23], v4, s[60:63], s36 offen offset:1280
    buffer_load_dword v43, v5, s[60:63], s36 offen offset:2304
    s_mov_b32 s36, 5120
    buffer_load_dwordx4 v[24:27], v4, s[60:63], s36 offen offset:0
    buffer_load_dword v44, v5, s[60:63], s36 offen offset:1024
    buffer_load_dwordx4 v[28:31], v4, s[60:63], s36 offen offset:1280
    buffer_load_dword v45, v5, s[60:63], s36 offen offset:2304
    s_mov_b32 s36, 7680
    buffer_load_dwordx4 v[32:35], v4, s[60:63], s36 offen offset:0
    buffer_load_dword v46, v5, s[60:63], s36 offen offset:1024
    buffer_load_dwordx4 v[36:39], v4, s[60:63], s36 offen offset:1280
    buffer_load_dword v47, v5, s[60:63], s36 offen offset:2304
    s_cmp_eq_u32 s32, 0
    s_cbranch_scc1 M_L2
    s_barrier
M_L2:
    ds_read_b32 v7, v1 offset:128
    s_waitcnt lgkmcnt(0)
    v_readfirstlane_b32 s31, v7
    s_waitcnt vmcnt(32)
    v_perm_b32 v128, v92, v88, s38
    v_perm_b32 v129, v100, v96, s38
    v_perm_b32 v130, v108, v104, s38
    v_perm_b32 v131, v116, v112, s38
    v_perm_b32 v132, v92, v88, s39
    v_perm_b32 v133, v100, v96, s39
    v_perm_b32 v134, v108, v104, s39
    v_perm_b32 v135, v116, v112, s39
    v_perm_b32 v136, v93, v89, s38
    v_perm_b32 v137, v101, v97, s38
    v_perm_b32 v138, v109, v105, s38
    v_perm_b32 v139, v117, v113, s38
    v_perm_b32 v140, v93, v89, s39
    v_perm_b32 v141, v101, v97, s39
    v_perm_b32 v142, v109, v105, s39
    v_perm_b32 v143, v117, v113, s39
    v_perm_b32 v144, v94, v90, s38
    v_perm_b32 v145, v102, v98, s38
    v_perm_b32 v146, v110, v106, s38
    v_perm_b32 v147, v118, v114, s38
    v_perm_b32 v148, v94, v90, s39
    v_perm_b32 v149, v102, v98, s39
    v_perm_b32 v150, v110, v106, s39
    v_perm_b32 v151, v118, v114, s39
    v_perm_b32 v152, v95, v91, s38
    v_perm_b32 v153, v103, v99, s38
    v_perm_b32 v154, v111, v107, s38
    v_perm_b32 v155, v119, v115, s38
    v_perm_b32 v156, v95, v91, s39
    v_perm_b32 v157, v103, v99, s39
    v_perm_b32 v158, v111, v107, s39
    v_perm_b32 v159, v119, v115, s39
    v_perm_b32 v160, v121, v120, s38
    v_perm_b32 v161, v123, v122, s38
    v_perm_b32 v162, v125, v124, s38
    v_perm_b32 v163, v127, v126, s38
    v_perm_b32 v164, v121, v120, s39
    v_perm_b32 v165, v123, v122, s39
    v_perm_b32 v166, v125, v124, s39
    v_perm_b32 v167, v127, v126, s39
    s_waitcnt vmcnt(16)
    v_perm_b32 v88, v52, v48, s38
    v_perm_b32 v89, v60, v56, s38
    v_perm_b32 v90, v68, v64, s38
    v_perm_b32 v91, v76, v72, s38
    v_perm_b32 v92, v52, v48, s39
    v_perm_b32 v93, v60, v56, s39
    v_perm_b32 v94, v68, v64, s39
    v_perm_b32 v95, v76, v72, s39
    v_perm_b32 v96, v53, v49, s38
    v_perm_b32 v97, v61, v57, s38
    v_perm_b32 v98, v69, v65, s38
    v_perm_b32 v99, v77, v73, s38
    v_perm_b32 v100, v53, v49, s39
    v_perm_b32 v101, v61, v57, s39
    v_perm_b32 v102, v69, v65, s39
    v_perm_b32 v103, v77, v73, s39
    v_perm_b32 v104, v54, v50, s38
    v_perm_b32 v105, v62, v58, s38
    v_perm_b32 v106, v70, v66, s38
    v_perm_b32 v107, v78, v74, s38
    v_perm_b32 v108, v54, v50, s39
    v_perm_b32 v109, v62, v58, s39
    v_perm_b32 v110, v70, v66, s39
    v_perm_b32 v111, v78, v74, s39
    v_perm_b32 v112, v55, v51, s38
    v_perm_b32 v113, v63, v59, s38
    v_perm_b32 v114, v71, v67, s38
    v_perm_b32 v115, v79, v75, s38
    v_perm_b32 v116, v55, v51, s39
    v_perm_b32 v117, v63, v59, s39
    v_perm_b32 v118, v71, v67, s39
    v_perm_b32 v119, v79, v75, s39
    v_perm_b32 v120, v81, v80, s38
    v_perm_b32 v121, v83, v82, s38
    v_perm_b32 v122, v85, v84, s38
    v_perm_b32 v123, v87, v86, s38
    v_perm_b32 v124, v81, v80, s39
    v_perm_b32 v125, v83, v82, s39
    v_perm_b32 v126, v85, v84, s39
    v_perm_b32 v127, v87, v86, s39
    s_waitcnt vmcnt(0)
    v_perm_b32 v48, v12, v8, s38
    v_perm_b32 v49, v20, v16, s38
    v_perm_b32 v50, v28, v24, s38
    v_perm_b32 v51, v36, v32, s38
    v_perm_b32 v52, v12, v8, s39
    v_perm_b32 v53, v20, v16, s39
    v_perm_b32 v54, v28, v24, s39
    v_perm_b32 v55, v36, v32, s39
    v_perm_b32 v56, v13, v9, s38
    v_perm_b32 v57, v21, v17, s38
    v_perm_b32 v58, v29, v25, s38
    v_perm_b32 v59, v37, v33, s38
    v_perm_b32 v60, v13, v9, s39
    v_perm_b32 v61, v21, v17, s39
    v_perm_b32 v62, v29, v25, s39
    v_perm_b32 v63, v37, v33, s39
    v_perm_b32 v64, v14, v10, s38
    v_perm_b32 v65, v22, v18, s38
    v_perm_b32 v66, v30, v26, s38
    v_perm_b32 v67, v38, v34, s38
    v_perm_b32 v68, v14, v10, s39
    v_perm_b32 v69, v22, v18, s39
    v_perm_b32 v70, v30, v26, s39
    v_perm_b32 v71, v38, v34, s39
    v_perm_b32 v72, v15, v11, s38
    v_perm_b32 v73, v23, v19, s38
    v_perm_b32 v74, v31, v27, s38
    v_perm_b32 v75, v39, v35, s38
    v_perm_b32 v76, v15, v11, s39
    v_perm_b32 v77, v23, v19, s39
    v_perm_b32 v78, v31, v27, s39
    v_perm_b32 v79, v39, v35, s39
    v_perm_b32 v80, v41, v40, s38
    v_perm_b32 v81, v43, v42, s38
    v_perm_b32 v82, v45, v44, s38
    v_perm_b32 v83, v47, v46, s38
    v_perm_b32 v84, v41, v40, s39
    v_perm_b32 v85, v43, v42, s39
    v_perm_b32 v86, v45, v44, s39
    v_perm_b32 v87, v47, v46, s39
    v_bfe_u32 v8, v0, 4, 1
    v_and_b32 v9, 15, v0
    v_lshrrev_b32 v10, 5, v0
    v_lshlrev_b32 v5, 4, v8
    v_lshl_add_u32 v5, v9, 5, v5
    v_mul_u32_u24 v11, 768, v10
    s_mul_i32 s37, s3, 1536
    s_and_b32 s40, s29, 1
    s_mul_i32 s41, s40, 384
    s_add_u32 s37, s37, s41
    v_add3_u32 v5, v5, v11, s37
    s_lshl_b32 s40, 460175067, s40
    v_mul_u32_u24 v7, 1088, v8
    v_lshl_add_u32 v7, v9, 4, v7
    v_lshl_add_u32 v7, v10, 1, v7
    s_lshl_b32 s37, s3, 2
    v_add3_u32 v7, v7, v1, s37
    v_lshlrev_b32 v4, 2, v0
    s_mul_i32 s41, s28, 61440
    s_add_u32 s41, s41, 8912896
    s_lshl_b32 s42, s28, 7
    s_add_u32 s42, s42, 8847360
    s_mov_b32 s37, 0xbfb8aa3b
    s_mov_b32 exec_lo, 0x0fff0fff
    s_mov_b32 exec_hi, 0x0fff0fff
    s_mov_b32 s36, s41
    buffer_load_dwordx4 v[8:11], v5, s[48:51], s36 offen sc1
    s_add_u32 s36, s36, 6144
    buffer_load_dwordx4 v[12:15], v5, s[48:51], s36 offen sc1
    s_add_u32 s36, s36, 6144
    buffer_load_dwordx4 v[16:19], v5, s[48:51], s36 offen sc1
    s_add_u32 s36, s36, 6144
    buffer_load_dwordx4 v[20:23], v5, s[48:51], s36 offen sc1
    s_add_u32 s36, s36, 6144
    buffer_load_dwordx4 v[24:27], v5, s[48:51], s36 offen sc1
    s_add_u32 s36, s36, 6144
    buffer_load_dwordx4 v[28:31], v5, s[48:51], s36 offen sc1
    s_add_u32 s36, s36, 6144
    buffer_load_dwordx4 v[32:35], v5, s[48:51], s36 offen sc1
    s_add_u32 s36, s36, 6144
    buffer_load_dwordx4 v[36:39], v5, s[48:51], s36 offen sc1
    s_add_u32 s36, s36, 6144
    buffer_load_dwordx4 v[40:43], v5, s[48:51], s36 offen sc1
    s_add_u32 s36, s36, 6144
    buffer_load_dwordx4 v[44:47], v5, s[48:51], s36 offen sc1
    s_mov_b32 exec_lo, s40
    s_mov_b32 exec_hi, 0
    buffer_load_dword v8, v4, s[48:51], s42 offen sc1
    s_mov_b64 exec, -1
    s_waitcnt vmcnt(0)
    v_and_b32 v4, 7, v0
    v_lshlrev_b32 v4, 3, v4
    s_mov_b32 s36, 8402944
    s_mov_b32 s46, 1048576
PF_17:
    buffer_load_dwordx2 v[6:7], v4, s[48:51], s36 offen sc1
    s_sub_u32 s46, s46, 1
    s_cbranch_scc1 PF_18
    s_waitcnt vmcnt(0)
    v_cmp_ne_u32 vcc, s31, v7
    s_cbranch_vccz PF_18
    s_sleep 3
    s_branch PF_17
PF_18:
    s_waitcnt vmcnt(0)
    s_lshl_b32 s38, s28, 2
    s_and_b32 s39, s29, 3
    s_add_u32 s38, s38, s39
    s_lshl_b32 s38, s38, 6
    v_add_u32 v5, s38, v0
    v_lshlrev_b32 v4, 2, v5
    s_mov_b32 s36, 8413184
    buffer_load_dword v10, v4, s[48:51], s36 offen sc1
    v_lshlrev_b32 v4, 3, v5
    s_mov_b32 s36, 8454144
    s_mov_b32 s46, 1048576
PF_19:
    buffer_load_dwordx2 v[8:9], v4, s[48:51], s36 offen sc1
    s_sub_u32 s46, s46, 1
    s_cbranch_scc1 PF_20
    s_waitcnt vmcnt(0)
    v_cmp_ne_u32 vcc, s31, v9
    s_cbranch_vccz PF_20
    s_sleep 3
    s_branch PF_19
PF_20:
    s_waitcnt vmcnt(0)
    v_lshlrev_b32 v8, 16, v8
    v_sub_u32 v5, 0xffff, v5
    v_mov_b32 v9, 0
    v_readlane_b32 s36, v6, 0
    s_nop 0
    s_and_b32 s36, s36, 0xffff
    v_mov_b32 v10, 320
    v_cmp_eq_u32 vcc, s36, v5
    s_nop 1
    v_cndmask_b32 v9, v9, v10, vcc
    v_readlane_b32 s36, v6, 1
    s_nop 0
    s_and_b32 s36, s36, 0xffff
    v_mov_b32 v10, 640
    v_cmp_eq_u32 vcc, s36, v5
    s_nop 1
    v_cndmask_b32 v9, v9, v10, vcc
    v_readlane_b32 s36, v6, 2
    s_nop 0
    s_and_b32 s36, s36, 0xffff
    v_mov_b32 v10, 960
    v_cmp_eq_u32 vcc, s36, v5
    s_nop 1
    v_cndmask_b32 v9, v9, v10, vcc
    v_readlane_b32 s36, v6, 3
    s_nop 0
    s_and_b32 s36, s36, 0xffff
    v_mov_b32 v10, 1280
    v_cmp_eq_u32 vcc, s36, v5
    s_nop 1
    v_cndmask_b32 v9, v9, v10, vcc
    v_readlane_b32 s36, v6, 4
    s_nop 0
    s_and_b32 s36, s36, 0xffff
    v_mov_b32 v10, 1600
    v_cmp_eq_u32 vcc, s36, v5
    s_nop 1
    v_cndmask_b32 v9, v9, v10, vcc
    v_readlane_b32 s36, v6, 5
    s_nop 0
    s_and_b32 s36, s36, 0xffff
    v_mov_b32 v10, 1920
    v_cmp_eq_u32 vcc, s36, v5
    s_nop 1
    v_cndmask_b32 v9, v9, v10, vcc
    v_readlane_b32 s36, v6, 6
    s_nop 0
    s_and_b32 s36, s36, 0xffff
    v_mov_b32 v10, 2240
    v_cmp_eq_u32 vcc, s36, v5
    s_nop 1
    v_cndmask_b32 v9, v9, v10, vcc
    v_readlane_b32 s36, v6, 7
    s_nop 0
    s_and_b32 s36, s36, 0xffff
    v_mov_b32 v10, 2560
    v_cmp_eq_u32 vcc, s36, v5
    s_nop 1
    v_cndmask_b32 v9, v9, v10, vcc
    v_lshl_add_u32 v4, v0, 3, v1
    ds_write_b64 v4, v[8:9] offset:288
    s_waitcnt lgkmcnt(0)
    s_mov_b64 exec, 1
    ds_add_u32 v1, v2 offset:24
    s_mov_b64 exec, -1
    v_bfe_u32 v8, v0, 4, 1
    v_and_b32 v9, 15, v0
    v_lshrrev_b32 v10, 5, v0
    v_lshlrev_b32 v5, 4, v8
    v_lshl_add_u32 v5, v9, 5, v5
    v_mul_u32_u24 v11, 768, v10
    s_mul_i32 s37, s3, 1536
    s_and_b32 s40, s29, 1
    s_mul_i32 s41, s40, 384
    s_add_u32 s37, s37, s41
    v_add3_u32 v5, v5, v11, s37
    s_lshl_b32 s40, 460175067, s40
    v_mul_u32_u24 v7, 1088, v8
    v_lshl_add_u32 v7, v9, 4, v7
    v_lshl_add_u32 v7, v10, 1, v7
    s_lshl_b32 s37, s3, 2
    v_add3_u32 v7, v7, v1, s37
    v_lshlrev_b32 v4, 2, v0
    s_mul_i32 s41, s28, 61440
    s_add_u32 s41, s41, 8912896
    s_lshl_b32 s42, s28, 7
    s_add_u32 s42, s42, 8847360
    s_mov_b32 s37, 0xbfb8aa3b
    s_mov_b32 s46, 16777216
LW_21:
    ds_read_b32 v8, v1 offset:64
    s_sub_u32 s46, s46, 1
    s_cbranch_scc1 LW_22
    s_waitcnt lgkmcnt(0)
    v_readfirstlane_b32 s47, v8
    s_nop 0
    s_cmp_ge_u32 s47, 1
    s_cbranch_scc1 LW_22
    s_sleep 4
    s_branch LW_21
LW_22:
    s_mov_b32 exec_lo, s40
    s_mov_b32 exec_hi, 0
    s_mov_b32 s46, 1048576
PF_23:
    buffer_load_dword v8, v4, s[48:51], s42 offen sc1
    s_sub_u32 s46, s46, 1
    s_cbranch_scc1 PF_24
    s_waitcnt vmcnt(0)
    v_cmp_ne_u32 vcc, s31, v8
    s_cbranch_vccz PF_24
    s_sleep 1
    s_branch PF_23
PF_24:
    s_waitcnt vmcnt(0)
    s_setprio 3
    s_mov_b32 exec_lo, 0x0fff0fff
    s_mov_b32 exec_hi, 0x0fff0fff
    s_mov_b32 s36, s41
    buffer_load_dwordx4 v[8:11], v5, s[48:51], s36 offen sc1
    s_add_u32 s36, s36, 6144
    buffer_load_dwordx4 v[12:15], v5, s[48:51], s36 offen sc1
    s_add_u32 s36, s36, 6144
    buffer_load_dwordx4 v[16:19], v5, s[48:51], s36 offen sc1
    s_add_u32 s36, s36, 6144
    buffer_load_dwordx4 v[20:23], v5, s[48:51], s36 offen sc1
    s_add_u32 s36, s36, 6144
    buffer_load_dwordx4 v[24:27], v5, s[48:51], s36 offen sc1
    s_add_u32 s36, s36, 6144
    buffer_load_dwordx4 v[28:31], v5, s[48:51], s36 offen sc1
    s_add_u32 s36, s36, 6144
    buffer_load_dwordx4 v[32:35], v5, s[48:51], s36 offen sc1
    s_add_u32 s36, s36, 6144
    buffer_load_dwordx4 v[36:39], v5, s[48:51], s36 offen sc1
    s_add_u32 s36, s36, 6144
    buffer_load_dwordx4 v[40:43], v5, s[48:51], s36 offen sc1
    s_add_u32 s36, s36, 6144
    buffer_load_dwordx4 v[44:47], v5, s[48:51], s36 offen sc1
    s_waitcnt vmcnt(5)
    v_pk_add_f32 v[8:9], v[8:9], v[12:13]
    v_pk_add_f32 v[10:11], v[10:11], v[14:15]
    v_pk_add_f32 v[16:17], v[16:17], v[20:21]
    v_pk_add_f32 v[18:19], v[18:19], v[22:23]
    v_pk_add_f32 v[8:9], v[8:9], v[24:25]
    v_pk_add_f32 v[10:11], v[10:11], v[26:27]
    v_pk_add_f32 v[8:9], v[8:9], v[16:17]
    v_pk_add_f32 v[10:11], v[10:11], v[18:19]
    v_cvt_pk_bf16_f32 v8, v8, v8
    v_and_b32 v8, 0xffff0000, v8
    v_cvt_pk_bf16_f32 v9, v9, v9
    v_and_b32 v9, 0xffff0000, v9
    v_cvt_pk_bf16_f32 v10, v10, v10
    v_and_b32 v10, 0xffff0000, v10
    v_cvt_pk_bf16_f32 v11, v11, v11
    v_and_b32 v11, 0xffff0000, v11
    v_mul_f32 v12, s37, v8
    v_mul_f32 v13, s37, v9
    v_mul_f32 v14, s37, v10
    v_mul_f32 v15, s37, v11
    v_exp_f32 v12, v12
    v_exp_f32 v13, v13
    v_exp_f32 v14, v14
    v_exp_f32 v15, v15
    v_add_f32 v12, 1.0, v12
    v_add_f32 v13, 1.0, v13
    v_add_f32 v14, 1.0, v14
    v_add_f32 v15, 1.0, v15
    v_rcp_f32 v12, v12
    v_rcp_f32 v13, v13
    v_rcp_f32 v14, v14
    v_rcp_f32 v15, v15
    v_mul_f32 v8, v8, v12
    v_mul_f32 v9, v9, v13
    v_mul_f32 v10, v10, v14
    v_mul_f32 v11, v11, v15
    v_cvt_pk_bf16_f32 v8, v8, v8
    v_and_b32 v8, 0xffff0000, v8
    v_cvt_pk_bf16_f32 v9, v9, v9
    v_and_b32 v9, 0xffff0000, v9
    v_cvt_pk_bf16_f32 v10, v10, v10
    v_and_b32 v10, 0xffff0000, v10
    v_cvt_pk_bf16_f32 v11, v11, v11
    v_and_b32 v11, 0xffff0000, v11
    s_waitcnt vmcnt(0)
    v_pk_add_f32 v[28:29], v[28:29], v[32:33]
    v_pk_add_f32 v[30:31], v[30:31], v[34:35]
    v_pk_add_f32 v[36:37], v[36:37], v[40:41]
    v_pk_add_f32 v[38:39], v[38:39], v[42:43]
    v_pk_add_f32 v[28:29], v[28:29], v[44:45]
    v_pk_add_f32 v[30:31], v[30:31], v[46:47]
    v_pk_add_f32 v[28:29], v[28:29], v[36:37]
    v_pk_add_f32 v[30:31], v[30:31], v[38:39]
    v_cvt_pk_bf16_f32 v28, v28, v28
    v_and_b32 v28, 0xffff0000, v28
    v_cvt_pk_bf16_f32 v29, v29, v29
    v_and_b32 v29, 0xffff0000, v29
    v_cvt_pk_bf16_f32 v30, v30, v30
    v_and_b32 v30, 0xffff0000, v30
    v_cvt_pk_bf16_f32 v31, v31, v31
    v_and_b32 v31, 0xffff0000, v31
    v_mul_f32 v8, v8, v28
    v_cvt_pk_bf16_f32 v8, v8, v8
    ds_write_b16 v7, v8 offset:1120
    v_mul_f32 v9, v9, v29
    v_cvt_pk_bf16_f32 v9, v9, v9
    ds_write_b16 v7, v9 offset:1392
    v_mul_f32 v10, v10, v30
    v_cvt_pk_bf16_f32 v10, v10, v10
    ds_write_b16 v7, v10 offset:1664
    v_mul_f32 v11, v11, v31
    v_cvt_pk_bf16_f32 v11, v11, v11
    ds_write_b16 v7, v11 offset:1936
    s_mov_b64 exec, -1
    s_mov_b64 exec, 1
    ds_add_u32 v1, v2 offset:56
    s_mov_b64 exec, -1
    v_and_b32 v4, 7, v0
    v_lshrrev_b32 v5, 4, v0
    v_mul_u32_u24 v4, 272, v4
    v_lshl_add_u32 v4, v5, 4, v4
    v_add_u32 v4, v4, v1
    v_and_b32 v5, 1, v5
    v_mul_u32_u24 v7, 10240, v5
    v_and_b32 v8, 15, v0
    v_lshrrev_b32 v9, 5, v0
    v_mul_u32_u24 v5, 5120, v9
    v_lshl_add_u32 v5, v8, 3, v5
    v_add_u32 v5, v5, v7
    v_lshl_add_u32 v7, v8, 4, v7
    v_lshl_add_u32 v7, v9, 8, v7
    s_mul_i32 s40, s32, 20480
    s_add_u32 s40, s40, 8519680
    s_lshl_b32 s36, s3, 7
    s_add_u32 s41, s40, s36
    s_add_u32 s41, s41, 2048
    s_lshl_b32 s36, s3, 9
    s_add_u32 s40, s40, s36
    s_mov_b32 s42, 0
    s_mov_b32 s43, -1
    s_mov_b32 s46, 16777216
LW_25:
    ds_read_b32 v8, v1 offset:56
    s_sub_u32 s46, s46, 1
    s_cbranch_scc1 LW_26
    s_waitcnt lgkmcnt(0)
    v_readfirstlane_b32 s47, v8
    s_nop 0
    s_cmp_ge_u32 s47, 4
    s_cbranch_scc0 LW_25
LW_26:
    ds_read_b128 v[8:11], v4 offset:1120
    ds_read_b128 v[12:15], v4 offset:1184
    ds_read_b128 v[16:19], v4 offset:1248
    s_mov_b64 exec, 1
    ds_add_u32 v1, v2 offset:56
    s_mov_b64 exec, -1
    s_waitcnt lgkmcnt(0)
    v_mfma_f32_16x16x32_bf16 v[20:23], v[8:11], v[48:51], 0
    v_mfma_f32_16x16x32_bf16 v[24:27], v[8:11], v[52:55], 0
    v_mfma_f32_16x16x32_bf16 v[28:31], v[8:11], v[56:59], 0
    v_mfma_f32_16x16x32_bf16 v[32:35], v[8:11], v[60:63], 0
    v_mfma_f32_16x16x32_bf16 v[36:39], v[8:11], v[64:67], 0
    v_mfma_f32_16x16x32_bf16 v[40:43], v[8:11], v[68:71], 0
    v_mfma_f32_16x16x32_bf16 v[44:47], v[8:11], v[72:75], 0
    v_mfma_f32_16x16x32_bf16 v[48:51], v[8:11], v[76:79], 0
    v_mfma_f32_16x16x32_bf16 v[52:55], v[8:11], v[80:83], 0
    v_mfma_f32_16x16x32_bf16 v[56:59], v[8:11], v[84:87], 0
    v_mfma_f32_16x16x32_bf16 v[20:23], v[12:15], v[88:91], v[20:23]
    v_mfma_f32_16x16x32_bf16 v[24:27], v[12:15], v[92:95], v[24:27]
    v_mfma_f32_16x16x32_bf16 v[28:31], v[12:15], v[96:99], v[28:31]
    v_mfma_f32_16x16x32_bf16 v[32:35], v[12:15], v[100:103], v[32:35]
    v_mfma_f32_16x16x32_bf16 v[36:39], v[12:15], v[104:107], v[36:39]
    v_mfma_f32_16x16x32_bf16 v[40:43], v[12:15], v[108:111], v[40:43]
    v_mfma_f32_16x16x32_bf16 v[44:47], v[12:15], v[112:115], v[44:47]
    v_mfma_f32_16x16x32_bf16 v[48:51], v[12:15], v[116:119], v[48:51]
    v_mfma_f32_16x16x32_bf16 v[52:55], v[12:15], v[120:123], v[52:55]
    v_mfma_f32_16x16x32_bf16 v[56:59], v[12:15], v[124:127], v[56:59]
    v_mfma_f32_16x16x32_bf16 v[20:23], v[16:19], v[128:131], v[20:23]
    v_mfma_f32_16x16x32_bf16 v[24:27], v[16:19], v[132:135], v[24:27]
    v_mfma_f32_16x16x32_bf16 v[28:31], v[16:19], v[136:139], v[28:31]
    v_mfma_f32_16x16x32_bf16 v[32:35], v[16:19], v[140:143], v[32:35]
    v_mfma_f32_16x16x32_bf16 v[36:39], v[16:19], v[144:147], v[36:39]
    v_mfma_f32_16x16x32_bf16 v[40:43], v[16:19], v[148:151], v[40:43]
    v_mfma_f32_16x16x32_bf16 v[44:47], v[16:19], v[152:155], v[44:47]
    v_mfma_f32_16x16x32_bf16 v[48:51], v[16:19], v[156:159], v[48:51]
    v_mfma_f32_16x16x32_bf16 v[52:55], v[16:19], v[160:163], v[52:55]
    v_mfma_f32_16x16x32_bf16 v[56:59], v[16:19], v[164:167], v[56:59]
    s_nop 2
    v_cndmask_b32 v60, v20, v36, s[42:43]
    v_cndmask_b32 v61, v24, v40, s[42:43]
    v_cndmask_b32 v62, v28, v44, s[42:43]
    v_cndmask_b32 v63, v32, v48, s[42:43]
    buffer_store_dwordx4 v[60:63], v7, s[48:51], s40 offen offset:0 sc1
    v_cndmask_b32 v64, v21, v37, s[42:43]
    v_cndmask_b32 v65, v25, v41, s[42:43]
    v_cndmask_b32 v66, v29, v45, s[42:43]
    v_cndmask_b32 v67, v33, v49, s[42:43]
    buffer_store_dwordx4 v[64:67], v7, s[48:51], s40 offen offset:2560 sc1
    v_cndmask_b32 v68, v22, v38, s[42:43]
    v_cndmask_b32 v69, v26, v42, s[42:43]
    v_cndmask_b32 v70, v30, v46, s[42:43]
    v_cndmask_b32 v71, v34, v50, s[42:43]
    s_add_u32 s40, s40, 5120
    buffer_store_dwordx4 v[68:71], v7, s[48:51], s40 offen offset:0 sc1
    v_cndmask_b32 v72, v23, v39, s[42:43]
    v_cndmask_b32 v73, v27, v43, s[42:43]
    v_cndmask_b32 v74, v31, v47, s[42:43]
    v_cndmask_b32 v75, v35, v51, s[42:43]
    buffer_store_dwordx4 v[72:75], v7, s[48:51], s40 offen offset:2560 sc1
    v_cndmask_b32 v76, v52, v54, s[42:43]
    v_cndmask_b32 v77, v56, v58, s[42:43]
    buffer_store_dwordx2 v[76:77], v5, s[48:51], s41 offen offset:0 sc1
    v_cndmask_b32 v78, v53, v55, s[42:43]
    v_cndmask_b32 v79, v57, v59, s[42:43]
    buffer_store_dwordx2 v[78:79], v5, s[48:51], s41 offen offset:2560 sc1
    s_waitcnt vmcnt(0)
    s_mov_b64 exec, 1
    ds_add_rtn_u32 v4, v1, v2 offset:60
    s_mov_b64 exec, -1
    s_waitcnt lgkmcnt(0)
    v_readfirstlane_b32 s47, v4
    s_nop 0
    s_cmp_lg_u32 s47, 3
    s_cbranch_scc1 M_FIN
    s_lshl_b32 s36, s32, 7
    s_add_u32 s36, s36, 8404992
    v_mov_b32 v4, s31
    s_mov_b64 exec, 1
    buffer_store_dword v4, off, s[48:51], s36 sc1
    s_mov_b64 exec, -1
M_FIN:
    s_mov_b32 s46, 16777216
LW_27:
    ds_read_b32 v4, v1 offset:56
    s_sub_u32 s46, s46, 1
    s_cbranch_scc1 LW_28
    s_waitcnt lgkmcnt(0)
    v_readfirstlane_b32 s47, v4
    s_nop 0
    s_cmp_ge_u32 s47, 8
    s_cbranch_scc1 LW_28
    s_sleep 1
    s_branch LW_27
LW_28:
    s_setprio 0
    s_mov_b32 s68, 0
    v_not_b32 v12, s31
    s_branch A_YH
R_M:
    s_setprio 3
    s_mov_b32 s56, s12
    s_mov_b32 s57, s13
    s_mov_b32 s58, 1280
    s_mov_b32 s59, 0x20000
    s_mov_b32 s60, s20
    s_mov_b32 s61, s21
    s_mov_b32 s62, 1280
    s_mov_b32 s63, 0x20000
    v_and_b32 v5, 31, v0
    v_lshlrev_b32 v5, 4, v5
    v_lshrrev_b32 v4, 5, v0
    s_lshl_b32 s38, s28, 8
    s_lshl_b32 s39, s29, 3
    s_add_u32 s38, s38, s39
    s_lshl_b32 s39, s30, 1
    s_add_u32 s38, s38, s39
    s_sub_u32 s38, s38, 8
    v_add_u32 v4, s38, v4
    v_mul_u32_u24 v6, 1280, v4
    v_add_u32 v6, v6, v5
    v_bfe_u32 v7, v0, 4, 1
    v_lshl_or_b32 v7, v7, 30, v6
    buffer_load_dwordx4 v[8:11], v6, s[52:55], 0 offen offset:0
    buffer_load_dwordx4 v[12:15], v6, s[52:55], 0 offen offset:512
    buffer_load_dwordx4 v[16:19], v7, s[52:55], 0 offen offset:1024
    buffer_load_dwordx4 v[20:23], v5, s[56:59], 0 offen offset:0
    buffer_load_dwordx4 v[32:35], v5, s[60:63], 0 offen offset:0
    buffer_load_dwordx4 v[24:27], v5, s[56:59], 0 offen offset:512
    buffer_load_dwordx4 v[36:39], v5, s[60:63], 0 offen offset:512
    buffer_load_dwordx4 v[28:31], v5, s[56:59], 0 offen offset:1024
    buffer_load_dwordx4 v[40:43], v5, s[60:63], 0 offen offset:1024
    s_add_u32 s36, s26, 8388608
    s_addc_u32 s37, s27, 0
    s_load_dword s31, s[36:37], 0
    s_cmp_eq_u32 s34, 0
    s_cbranch_scc1 RM_NSB
    s_barrier
RM_NSB:
    s_sub_u32 s10, 7, s30
    s_sub_u32 s38, s30, 4
    s_cmp_lt_u32 s30, 4
    s_cselect_b32 s10, s10, s38
    s_add_u32 s11, s10, 1
    s_cmp_eq_u32 s28, 0
    s_cselect_b32 s25, 0, 2
    s_cselect_b32 s38, s11, 9
    s_sub_u32 s25, s11, s25
    s_mov_b32 s11, s38
    s_mul_i32 s24, s29, 83200
    v_and_b32 v148, 31, v0
    v_lshrrev_b32 v149, 5, v0
    s_lshl_b32 s38, s10, 8
    v_lshl_add_u32 v133, v148, 3, s38
    v_lshl_add_u32 v132, v149, 13, v133
    v_bfe_u32 v134, v0, 4, 1
    v_and_b32 v150, 3, v0
    v_lshl_add_u32 v134, v134, 2, v150
    v_min_u32 v134, 5, v134
    v_mul_u32_u24 v134, 4128, v134
    v_bfe_u32 v151, v0, 2, 2
    v_lshl_add_u32 v152, v149, 2, v151
    v_lshl_add_u32 v134, v152, 3, v134
    v_add_u32 v134, s38, v134
    s_lshl_b32 s39, s28, 11
    v_add_u32 v136, s39, v133
    v_mul_u32_u24 v152, 33280, v149
    v_add_u32 v135, v152, v136
    v_lshrrev_b32 v137, 4, v0
    v_mul_u32_u24 v137, 16640, v137
    v_and_b32 v152, 15, v0
    v_lshl_add_u32 v137, v152, 4, v137
    s_add_u32 s39, s39, s38
    v_add_u32 v137, s39, v137
    v_lshl_or_b32 v136, v149, 30, v136
    v_lshlrev_b32 v152, 2, v149
    v_sub_u32 v152, v148, v152
    v_mov_b32 v138, 0xf149f2ca
    v_mov_b32 v146, 0
    v_cmp_le_i32 s[64:65], 0, v152
    v_cmp_le_i32 s[66:67], 1, v152
    v_cmp_le_i32 s[68:69], 2, v152
    v_cmp_le_i32 s[70:71], 3, v152
    v_cmp_le_i32 s[72:73], 8, v152
    v_cmp_le_i32 s[74:75], 9, v152
    v_cmp_le_i32 s[76:77], 10, v152
    v_cmp_le_i32 s[78:79], 11, v152
    v_cmp_le_i32 s[80:81], 16, v152
    v_cmp_le_i32 s[82:83], 17, v152
    v_cmp_le_i32 s[84:85], 18, v152
    v_cmp_le_i32 s[86:87], 19, v152
    v_cmp_le_i32 s[88:89], 24, v152
    v_cmp_le_i32 s[90:91], 25, v152
    v_cmp_le_i32 s[92:93], 26, v152
    v_cmp_le_i32 s[94:95], 27, v152
    s_and_b32 s39, s30, 3
    s_lshr_b32 s40, s30, 2
    s_lshl_b32 s38, s28, 2
    s_and_b32 s41, s29, 3
    s_add_u32 s38, s38, s41
    s_lshl_b32 s38, s38, 6
    v_lshrrev_b32 v148, 4, v0
    v_and_b32 v149, 15, v0
    s_lshl_b32 s41, s39, 4
    v_add_u32 v153, s41, v149
    v_lshl_add_u32 v144, v153, 3, v1
    v_mul_u32_u24 v143, 160, v153
    v_mul_u32_u24 v152, 40, v148
    v_add_u32 v143, v143, v152
    s_mul_i32 s42, s40, 24
    s_add_u32 s43, s42, 147648
    v_add_u32 v143, s43, v143
    v_add_u32 v153, s38, v153
    v_mul_u32_u24 v140, 1280, v153
    v_add_u32 v140, v140, v152
    s_lshr_b32 s43, s29, 2
    s_mul_i32 s43, s43, 160
    s_add_u32 s43, s43, s42
    v_add_u32 v140, s43, v140
    s_mul_i32 s43, s40, 1331200
    v_bfe_u32 v147, v0, 3, 1
    v_lshl_add_u32 v147, v147, 2, v148
    v_mul_u32_u24 v147, 83200, v147
    v_and_b32 v152, 7, v0
    v_lshl_add_u32 v147, v152, 4, v147
    s_add_u32 s44, s41, s38
    s_lshl_b32 s44, s44, 3
    s_add_u32 s44, s44, s43
    s_add_u32 s44, s44, 66560
    v_add_u32 v147, s44, v147
    v_lshrrev_b32 v152, 5, v0
    v_and_b32 v153, 1, v148
    v_mul_u32_u24 v139, 83200, v152
    v_mul_u32_u24 v141, 33280, v153
    v_add_u32 v139, v139, v141
    v_lshl_add_u32 v139, v149, 4, v139
    s_add_u32 s41, s41, s38
    s_lshr_b32 s41, s41, 5
    s_lshl_b32 s41, s41, 8
    s_add_u32 s41, s41, s43
    s_and_b32 s44, s39, 1
    s_mul_i32 s44, s44, 16640
    s_add_u32 s41, s41, s44
    v_add_u32 v139, s41, v139
    v_mul_u32_u24 v141, 20, v152
    v_lshl_add_u32 v141, v153, 2, v141
    v_add_u32 v141, v141, v151
    v_mul_u32_u24 v141, 160, v141
    v_mul_u32_u24 v150, 40, v150
    v_add_u32 v141, v141, v150
    s_mul_i32 s41, s40, 51200
    s_add_u32 s41, s41, 45248
    v_add_u32 v141, s41, v141
    s_mul_i32 s41, s39, 5120
    v_lshl_add_u32 v142, v0, 4, s41
    s_waitcnt lgkmcnt(0)
    s_mul_i32 s31, s31, 1664525
    s_add_u32 s31, s31, 1013904223
    v_mov_b32 v45, s31
    s_cmp_lg_u32 s30, 4
    s_cbranch_scc1 RM_N4
    s_getreg_b32 s39, hwreg(HW_REG_XCC_ID)
    v_mov_b32 v44, s39
    ds_write_b32 v1, v45 offset:128
    s_lshl_b32 s36, s28, 8
    s_lshl_b32 s37, s29, 3
    s_add_u32 s36, s36, s37
    s_add_u32 s36, s36, 8392704
    s_mov_b64 exec, 1
    buffer_store_dwordx2 v[44:45], off, s[48:51], s36 sc1
    s_mov_b64 exec, -1
    s_waitcnt vmcnt(1)
    s_branch RM_DOT
RM_N4:
    s_cmp_lg_u32 s30, 6
    s_cbranch_scc1 RM_N6
    v_mov_b32 v48, 0
    v_mov_b32 v49, 0
    v_mov_b32 v50, 0
    v_mov_b32 v51, 0
    v_lshl_add_u32 v46, v0, 4, v1
    s_mov_b64 exec, 0xff
    ds_write_b128 v46, v[48:51] offset:0
    s_mov_b64 exec, 0xfffff
    ds_write_b128 v46, v[48:51] offset:800
    s_mov_b64 exec, -1
RM_N6:
    s_waitcnt vmcnt(0)
RM_DOT:
    v_mov_b32 v46, 0
    v_mov_b32 v47, 0
    v_dot2_f32_bf16 v46, v8, v20, v46
    v_dot2_f32_bf16 v47, v8, v32, v47
    v_dot2_f32_bf16 v46, v9, v21, v46
    v_dot2_f32_bf16 v47, v9, v33, v47
    v_dot2_f32_bf16 v46, v10, v22, v46
    v_dot2_f32_bf16 v47, v10, v34, v47
    v_dot2_f32_bf16 v46, v11, v23, v46
    v_dot2_f32_bf16 v47, v11, v35, v47
    v_dot2_f32_bf16 v46, v12, v24, v46
    v_dot2_f32_bf16 v47, v12, v36, v47
    v_dot2_f32_bf16 v46, v13, v25, v46
    v_dot2_f32_bf16 v47, v13, v37, v47
    v_dot2_f32_bf16 v46, v14, v26, v46
    v_dot2_f32_bf16 v47, v14, v38, v47
    v_dot2_f32_bf16 v46, v15, v27, v46
    v_dot2_f32_bf16 v47, v15, v39, v47
    v_dot2_f32_bf16 v46, v16, v28, v46
    v_dot2_f32_bf16 v47, v16, v40, v47
    v_dot2_f32_bf16 v46, v17, v29, v46
    v_dot2_f32_bf16 v47, v17, v41, v47
    v_dot2_f32_bf16 v46, v18, v30, v46
    v_dot2_f32_bf16 v47, v18, v42, v47
    v_dot2_f32_bf16 v46, v19, v31, v46
    v_dot2_f32_bf16 v47, v19, v43, v47
    s_nop 1
    v_add_f32_dpp v46, v46, v46 row_ror:8 row_mask:0xf bank_mask:0xf
    v_add_f32_dpp v47, v47, v47 row_ror:8 row_mask:0xf bank_mask:0xf
    s_nop 0
    v_add_f32_dpp v46, v46, v46 row_ror:4 row_mask:0xf bank_mask:0xf
    v_add_f32_dpp v47, v47, v47 row_ror:4 row_mask:0xf bank_mask:0xf
    s_nop 0
    v_add_f32_dpp v46, v46, v46 row_ror:2 row_mask:0xf bank_mask:0xf
    v_add_f32_dpp v47, v47, v47 row_ror:2 row_mask:0xf bank_mask:0xf
    s_nop 0
    v_add_f32_dpp v46, v46, v46 row_ror:1 row_mask:0xf bank_mask:0xf
    v_add_f32_dpp v47, v47, v47 row_ror:1 row_mask:0xf bank_mask:0xf
    s_nop 0
    v_add_f32_dpp v46, v46, v46 row_bcast:15 row_mask:0xa bank_mask:0xf
    v_add_f32_dpp v47, v47, v47 row_bcast:15 row_mask:0xa bank_mask:0xf
    v_cvt_pk_bf16_f32 v46, v46, v46
    v_and_b32 v46, 0xffff0000, v46
    v_ashrrev_i32 v7, 31, v46
    v_or_b32 v7, 0x80000000, v7
    v_xor_b32 v7, v7, v46
    s_mov_b32 s37, 0xbfb8aa3b
    v_cvt_pk_bf16_f32 v47, v47, v47
    v_and_b32 v47, 0xffff0000, v47
    v_mul_f32 v47, s37, v47
    v_exp_f32 v47, v47
    s_nop 0
    v_add_f32 v47, 1.0, v47
    v_rcp_f32 v47, v47
    s_nop 0
    v_cvt_pk_bf16_f32 v47, v47, v47
    s_mov_b32 s37, 0xffff0000
    v_bfi_b32 v44, s37, v7, v47
    v_lshlrev_b32 v4, 3, v4
    s_mov_b32 s36, 8454144
    s_mov_b32 exec_lo, 0x80000000
    s_mov_b32 exec_hi, 0x80000000
    buffer_store_dwordx2 v[44:45], v4, s[48:51], s36 offen sc1
    s_mov_b64 exec, -1
    s_setprio 0
    s_waitcnt lgkmcnt(0)
    s_barrier
    s_mov_b32 s59, 9
    v_cndmask_b32 v42, v138, 0, s[64:65]
    v_cndmask_b32 v74, 0, v138, s[64:65]
    v_cndmask_b32 v43, v138, 0, s[66:67]
    v_cndmask_b32 v75, 0, v138, s[66:67]
    v_cndmask_b32 v44, v138, 0, s[68:69]
    v_cndmask_b32 v76, 0, v138, s[68:69]
    v_cndmask_b32 v45, v138, 0, s[70:71]
    v_cndmask_b32 v77, 0, v138, s[70:71]
    v_cndmask_b32 v46, v138, 0, s[72:73]
    v_cndmask_b32 v78, 0, v138, s[72:73]
    v_cndmask_b32 v47, v138, 0, s[74:75]
    v_cndmask_b32 v79, 0, v138, s[74:75]
    v_cndmask_b32 v48, v138, 0, s[76:77]
    v_cndmask_b32 v80, 0, v138, s[76:77]
    v_cndmask_b32 v49, v138, 0, s[78:79]
    v_cndmask_b32 v81, 0, v138, s[78:79]
    v_cndmask_b32 v50, v138, 0, s[80:81]
    v_cndmask_b32 v82, 0, v138, s[80:81]
    v_cndmask_b32 v51, v138, 0, s[82:83]
    v_cndmask_b32 v83, 0, v138, s[82:83]
    v_cndmask_b32 v52, v138, 0, s[84:85]
    v_cndmask_b32 v84, 0, v138, s[84:85]
    v_cndmask_b32 v53, v138, 0, s[86:87]
    v_cndmask_b32 v85, 0, v138, s[86:87]
    v_cndmask_b32 v54, v138, 0, s[88:89]
    v_cndmask_b32 v86, 0, v138, s[88:89]
    v_cndmask_b32 v55, v138, 0, s[90:91]
    v_cndmask_b32 v87, 0, v138, s[90:91]
    v_cndmask_b32 v56, v138, 0, s[92:93]
    v_cndmask_b32 v88, 0, v138, s[92:93]
    v_cndmask_b32 v57, v138, 0, s[94:95]
    v_cndmask_b32 v89, 0, v138, s[94:95]
    s_sub_u32 s35, s30, 4
    s_lshl_b32 s56, s28, 1
    s_add_u32 s56, s56, s35
    s_sub_u32 s56, s56, 2
    s_mul_i32 s40, s29, 5
    s_lshr_b32 s41, s40, 5
    s_add_u32 s40, s40, 4
    s_lshr_b32 s40, s40, 5
    s_lshl_b32 s41, 1, s41
    s_lshl_b32 s40, 1, s40
    s_or_b32 s40, s40, s41
    s_mul_i32 s41, s40, 1056
    s_or_b32 s40, s40, s41
    s_cmp_lt_u32 s35, 2
    s_cselect_b32 s57, s41, s40
    s_lshl_b32 s44, s56, 4
    v_add_u32 v145, s44, v0
    v_lshlrev_b32 v145, 7, v145
    s_lshl_b32 s43, s56, 10
    v_lshl_add_u32 v146, v0, 4, s43
    s_cmp_eq_u32 s30, 5
    s_cbranch_scc0 RM_BARL
    v_and_b32 v4, 31, v0
    v_lshlrev_b32 v4, 3, v4
    s_lshl_b32 s36, s28, 8
    s_add_u32 s36, s36, 8392704
    s_mov_b32 s46, 1048576
RM_CKL:
    buffer_load_dwordx2 v[6:7], v4, s[48:51], s36 offen sc1
    s_cmp_eq_u32 s59, 0
    s_cbranch_scc1 RM_CK2
    s_cmp_eq_u32 s34, 1
    s_cbranch_scc1 RM_CK2
    s_sub_u32 s59, s59, 1
    s_barrier
RM_CK2:
    s_sub_u32 s46, s46, 1
    s_cbranch_scc1 RM_CKD
    s_waitcnt vmcnt(0)
    v_cmp_ne_u32 vcc, s31, v7
    s_cbranch_vccz RM_CKD
    s_sleep 2
    s_branch RM_CKL
RM_CKD:
    s_waitcnt vmcnt(0)
    v_readfirstlane_b32 s38, v6
    s_nop 1
    v_cmp_ne_u32 vcc, s38, v6
    s_nop 0
    s_cmp_eq_u64 vcc, 0
    s_cselect_b32 s38, 1, 2
    v_mov_b32 v6, s38
    ds_write_b32 v1, v6 offset:32
RM_BARL:
    s_lshl_b32 s36, s28, 7
    s_add_u32 s36, s36, 8396800
    s_cmp_eq_u32 s34, 1
    s_cbranch_scc1 RM_SP
    s_lshl_b32 s38, s29, 4
    s_add_u32 s38, s38, s30
    s_cmp_eq_u32 s38, 7
    s_cselect_b32 s38, 0, 100
RM_BL:
    s_cmp_eq_u32 s59, 0
    s_cbranch_scc1 RM_RD
    s_sub_u32 s59, s59, 1
    s_barrier
    s_cmp_lg_u32 s59, s38
    s_cbranch_scc1 RM_BL
    v_mov_b32 v4, s31
    s_mov_b64 exec, 1
    buffer_store_dword v4, off, s[48:51], s36 sc1
    s_mov_b64 exec, -1
    s_branch RM_BL
RM_RD:
    s_mov_b32 s46, 16777216
LW_29:
    ds_read_b32 v4, v1 offset:4
    s_sub_u32 s46, s46, 1
    s_cbranch_scc1 LW_30
    s_waitcnt lgkmcnt(0)
    v_readfirstlane_b32 s47, v4
    s_nop 0
    s_cmp_ge_u32 s47, 4
    s_cbranch_scc1 LW_30
    s_sleep 2
    s_branch LW_29
LW_30:
    s_branch RM_P2
RM_SP:
    s_cmp_eq_u32 s30, 7
    s_cbranch_scc0 RM_SPW
    v_mov_b32 v4, 0
    s_mov_b64 exec, 1
    s_mov_b32 s46, 1048576
PF_31:
    buffer_load_dword v5, v4, s[48:51], s36 offen sc1
    s_sub_u32 s46, s46, 1
    s_cbranch_scc1 PF_32
    s_waitcnt vmcnt(0)
    v_cmp_ne_u32 vcc, s31, v5
    s_cbranch_vccz PF_32
    s_sleep 8
    s_branch PF_31
PF_32:
    s_waitcnt vmcnt(0)
    s_mov_b64 exec, -1
    s_mov_b64 exec, 1
    ds_add_u32 v1, v2 offset:64
    s_mov_b64 exec, -1
RM_SPW:
    s_mov_b32 s46, 16777216
LW_33:
    ds_read_b32 v4, v1 offset:64
    s_sub_u32 s46, s46, 1
    s_cbranch_scc1 LW_34
    s_waitcnt lgkmcnt(0)
    v_readfirstlane_b32 s47, v4
    s_nop 0
    s_cmp_ge_u32 s47, 1
    s_cbranch_scc1 LW_34
    s_sleep 4
    s_branch LW_33
LW_34:
RM_P2:
    v_mov_b32 v4, 0x3f80
    v_mov_b32 v5, 0
    v_mov_b32 v6, v4
    v_mov_b32 v7, v5
    s_lshl_b32 s58, s35, 10
    v_lshl_add_u32 v148, v0, 4, s58
    ds_write_b128 v148, v[4:7] offset:41120
    s_cmp_lt_i32 s56, 0
    s_cbranch_scc1 P2_WQ
    s_mov_b32 s42, 8421376
    s_mov_b32 exec_lo, s57
    s_mov_b32 exec_hi, 0
    s_mov_b32 s46, 1048576
RM_PL:
    buffer_load_dword v148, v145, s[48:51], s42 offen sc1
    s_sub_u32 s46, s46, 1
    s_cbranch_scc1 RM_PD
    s_waitcnt vmcnt(0)
    v_cmp_ne_u32 vcc, s31, v148
    s_nop 0
    s_and_b32 s40, vcc_lo, 65504
    s_cbranch_scc0 RM_PD
    s_sleep 0
    s_branch RM_PL
RM_PD:
    s_waitcnt vmcnt(0)
    s_mov_b32 s41, vcc_lo
    s_mov_b64 exec, -1
    s_cmp_lt_u32 s35, 2
    s_cbranch_scc1 P2_WQ
    s_lshl_b32 s40, s35, 2
    v_add_u32 v150, s40, v1
    s_cmp_lg_u32 s41, 0
    s_cbranch_scc1 RM_NQ
    ds_write_b32 v150, v2 offset:4
RM_NQ:
    s_add_u32 m0, s58, 0
    s_add_u32 s44, s24, 2662400
    buffer_load_dwordx4 v146, s[48:51], s44 offen sc1 lds
    s_add_u32 m0, s58, 4096
    s_add_u32 s44, s24, 2679040
    buffer_load_dwordx4 v146, s[48:51], s44 offen sc1 lds
    s_add_u32 m0, s58, 8192
    s_add_u32 s44, s24, 2695680
    buffer_load_dwordx4 v146, s[48:51], s44 offen sc1 lds
    s_add_u32 m0, s58, 12288
    s_add_u32 s44, s24, 2712320
    buffer_load_dwordx4 v146, s[48:51], s44 offen sc1 lds
    s_add_u32 m0, s58, 16384
    s_add_u32 s44, s24, 2728960
    buffer_load_dwordx4 v146, s[48:51], s44 offen sc1 lds
    s_add_u32 m0, s58, 20480
    s_add_u32 s44, s24, 5324800
    buffer_load_dwordx4 v146, s[48:51], s44 offen sc1 lds
    s_add_u32 m0, s58, 24608
    s_add_u32 s44, s24, 5341440
    buffer_load_dwordx4 v146, s[48:51], s44 offen sc1 lds
    s_add_u32 m0, s58, 28736
    s_add_u32 s44, s24, 5358080
    buffer_load_dwordx4 v146, s[48:51], s44 offen sc1 lds
    s_add_u32 m0, s58, 32864
    s_add_u32 s44, s24, 5374720
    buffer_load_dwordx4 v146, s[48:51], s44 offen sc1 lds
    s_add_u32 m0, s58, 36992
    s_add_u32 s44, s24, 5391360
    buffer_load_dwordx4 v146, s[48:51], s44 offen sc1 lds
    s_cmp_eq_u32 s41, 0
    s_cbranch_scc1 P2_WQ
    s_mov_b32 exec_lo, s41
    s_mov_b32 exec_hi, 0
    s_mov_b32 s46, 1048576
PF_35:
    buffer_load_dword v148, v145, s[48:51], s42 offen sc1
    s_sub_u32 s46, s46, 1
    s_cbranch_scc1 PF_36
    s_waitcnt vmcnt(0)
    v_cmp_ne_u32 vcc, s31, v148
    s_cbranch_vccnz PF_35
PF_36:
    s_waitcnt vmcnt(0)
    s_mov_b64 exec, -1
    ds_write_b32 v150, v2 offset:4
    s_branch P2_WQ
R_C:
    s_cmp_eq_u32 s34, 0
    s_cbranch_scc1 RC_NSB
    s_barrier
RC_NSB:
    s_cmp_lg_u32 s30, 1
    s_cbranch_scc1 RC_NC
    s_getpc_b64 s[36:37]
RC_PC:
    s_sub_u32 s36, s36, RC_PC-gated_mix__sliding_block__moe_arch_mod__prompt_kernel
    s_subb_u32 s37, s37, 0
    s_mul_i32 s38, s29, 1280
    v_lshl_add_u32 v130, v0, 6, s38
    v_min_u32 v130, K_END-gated_mix__sliding_block__moe_arch_mod__prompt_kernel, v130
    s_mov_b64 exec, 0xfffff
    global_load_dword v131, v130, s[36:37]
    s_mov_b64 exec, -1
    s_waitcnt vmcnt(0)
RC_NC:
    s_cmp_lg_u32 s30, 2
    s_cbranch_scc1 RC_NWM
    s_mul_i32 s38, s2, 3200
    v_lshlrev_b32 v130, 7, v0
    s_mov_b32 s56, s8
    s_mov_b32 s57, s9
    s_mov_b32 s58, 819200
    s_mov_b32 s59, 0x20000
    s_mov_b64 exec, 0x1ffffff
    buffer_load_dword v131, v130, s[56:59], s38 offen
    s_mov_b64 exec, -1
    s_mov_b32 s56, s18
    s_mov_b32 s57, s19
    s_mov_b32 s58, 1966080
    s_mov_b32 s59, 0x20000
    s_mul_i32 s38, s28, 245760
    s_mul_i32 s39, s29, 7680
    s_add_u32 s38, s38, s39
    s_mov_b32 exec_hi, 0xfffffff
    buffer_load_dword v131, v130, s[56:59], s38 offen
    s_mov_b64 exec, -1
    s_waitcnt vmcnt(0)
RC_NWM:
    s_sub_u32 s10, 7, s30
    s_sub_u32 s38, s30, 4
    s_cmp_lt_u32 s30, 4
    s_cselect_b32 s10, s10, s38
    s_add_u32 s11, s10, 1
    s_cmp_eq_u32 s28, 0
    s_cselect_b32 s25, 0, 2
    s_cselect_b32 s38, s11, 9
    s_sub_u32 s25, s11, s25
    s_mov_b32 s11, s38
    s_mul_i32 s24, s29, 83200
    v_and_b32 v148, 31, v0
    v_lshrrev_b32 v149, 5, v0
    s_lshl_b32 s38, s10, 8
    v_lshl_add_u32 v133, v148, 3, s38
    v_lshl_add_u32 v132, v149, 13, v133
    v_bfe_u32 v134, v0, 4, 1
    v_and_b32 v150, 3, v0
    v_lshl_add_u32 v134, v134, 2, v150
    v_min_u32 v134, 5, v134
    v_mul_u32_u24 v134, 4128, v134
    v_bfe_u32 v151, v0, 2, 2
    v_lshl_add_u32 v152, v149, 2, v151
    v_lshl_add_u32 v134, v152, 3, v134
    v_add_u32 v134, s38, v134
    s_lshl_b32 s39, s28, 11
    v_add_u32 v136, s39, v133
    v_mul_u32_u24 v152, 33280, v149
    v_add_u32 v135, v152, v136
    v_lshrrev_b32 v137, 4, v0
    v_mul_u32_u24 v137, 16640, v137
    v_and_b32 v152, 15, v0
    v_lshl_add_u32 v137, v152, 4, v137
    s_add_u32 s39, s39, s38
    v_add_u32 v137, s39, v137
    v_lshl_or_b32 v136, v149, 30, v136
    v_lshlrev_b32 v152, 2, v149
    v_sub_u32 v152, v148, v152
    v_mov_b32 v138, 0xf149f2ca
    v_mov_b32 v146, 0
    v_cmp_le_i32 s[64:65], 0, v152
    v_cmp_le_i32 s[66:67], 1, v152
    v_cmp_le_i32 s[68:69], 2, v152
    v_cmp_le_i32 s[70:71], 3, v152
    v_cmp_le_i32 s[72:73], 8, v152
    v_cmp_le_i32 s[74:75], 9, v152
    v_cmp_le_i32 s[76:77], 10, v152
    v_cmp_le_i32 s[78:79], 11, v152
    v_cmp_le_i32 s[80:81], 16, v152
    v_cmp_le_i32 s[82:83], 17, v152
    v_cmp_le_i32 s[84:85], 18, v152
    v_cmp_le_i32 s[86:87], 19, v152
    v_cmp_le_i32 s[88:89], 24, v152
    v_cmp_le_i32 s[90:91], 25, v152
    v_cmp_le_i32 s[92:93], 26, v152
    v_cmp_le_i32 s[94:95], 27, v152
    s_and_b32 s39, s30, 3
    s_lshr_b32 s40, s30, 2
    s_lshl_b32 s38, s28, 2
    s_and_b32 s41, s29, 3
    s_add_u32 s38, s38, s41
    s_lshl_b32 s38, s38, 6
    v_lshrrev_b32 v148, 4, v0
    v_and_b32 v149, 15, v0
    s_lshl_b32 s41, s39, 4
    v_add_u32 v153, s41, v149
    v_lshl_add_u32 v144, v153, 3, v1
    v_mul_u32_u24 v143, 160, v153
    v_mul_u32_u24 v152, 40, v148
    v_add_u32 v143, v143, v152
    s_mul_i32 s42, s40, 24
    s_add_u32 s43, s42, 147648
    v_add_u32 v143, s43, v143
    v_add_u32 v153, s38, v153
    v_mul_u32_u24 v140, 1280, v153
    v_add_u32 v140, v140, v152
    s_lshr_b32 s43, s29, 2
    s_mul_i32 s43, s43, 160
    s_add_u32 s43, s43, s42
    v_add_u32 v140, s43, v140
    s_mul_i32 s43, s40, 1331200
    v_bfe_u32 v147, v0, 3, 1
    v_lshl_add_u32 v147, v147, 2, v148
    v_mul_u32_u24 v147, 83200, v147
    v_and_b32 v152, 7, v0
    v_lshl_add_u32 v147, v152, 4, v147
    s_add_u32 s44, s41, s38
    s_lshl_b32 s44, s44, 3
    s_add_u32 s44, s44, s43
    s_add_u32 s44, s44, 66560
    v_add_u32 v147, s44, v147
    v_lshrrev_b32 v152, 5, v0
    v_and_b32 v153, 1, v148
    v_mul_u32_u24 v139, 83200, v152
    v_mul_u32_u24 v141, 33280, v153
    v_add_u32 v139, v139, v141
    v_lshl_add_u32 v139, v149, 4, v139
    s_add_u32 s41, s41, s38
    s_lshr_b32 s41, s41, 5
    s_lshl_b32 s41, s41, 8
    s_add_u32 s41, s41, s43
    s_and_b32 s44, s39, 1
    s_mul_i32 s44, s44, 16640
    s_add_u32 s41, s41, s44
    v_add_u32 v139, s41, v139
    v_mul_u32_u24 v141, 20, v152
    v_lshl_add_u32 v141, v153, 2, v141
    v_add_u32 v141, v141, v151
    v_mul_u32_u24 v141, 160, v141
    v_mul_u32_u24 v150, 40, v150
    v_add_u32 v141, v141, v150
    s_mul_i32 s41, s40, 51200
    s_add_u32 s41, s41, 45248
    v_add_u32 v141, s41, v141
    s_mul_i32 s41, s39, 5120
    v_lshl_add_u32 v142, v0, 4, s41
    s_cmp_eq_u32 s34, 1
    s_cbranch_scc0 RC_GEMM
    s_barrier
    ds_read_b32 v5, v1 offset:128
    s_waitcnt lgkmcnt(0)
    v_readfirstlane_b32 s31, v5
    s_setprio 3
    s_cmp_lg_u32 s32, 0
    s_cbranch_scc1 M_NOSEL
    v_lshlrev_b32 v4, 4, v0
    s_lshl_b32 s37, s30, 12
    s_add_u32 s37, s37, 8454144
    s_mov_b32 s46, 1048576
M_RP:
    buffer_load_dwordx4 v[16:19], v4, s[48:51], s37 offen offset:0 sc1
    buffer_load_dwordx4 v[20:23], v4, s[48:51], s37 offen offset:1024 sc1
    buffer_load_dwordx4 v[24:27], v4, s[48:51], s37 offen offset:2048 sc1
    buffer_load_dwordx4 v[28:31], v4, s[48:51], s37 offen offset:3072 sc1
    s_sub_u32 s46, s46, 1
    s_cbranch_scc1 M_RD
    s_waitcnt vmcnt(0)
    v_xor_b32 v5, s31, v17
    v_xor_b32 v6, s31, v19
    v_or_b32 v5, v5, v6
    v_xor_b32 v6, s31, v21
    v_or_b32 v5, v5, v6
    v_xor_b32 v6, s31, v23
    v_or_b32 v5, v5, v6
    v_xor_b32 v6, s31, v25
    v_or_b32 v5, v5, v6
    v_xor_b32 v6, s31, v27
    v_or_b32 v5, v5, v6
    v_xor_b32 v6, s31, v29
    v_or_b32 v5, v5, v6
    v_xor_b32 v6, s31, v31
    v_or_b32 v5, v5, v6
    v_cmp_ne_u32 vcc, 0, v5
    s_cbranch_vccz M_RD
    s_sleep 1
    s_branch M_RP
M_RD:
    s_waitcnt vmcnt(0)
    s_lshl_b32 s36, s30, 9
    s_sub_u32 s36, 0xffff, s36
    v_lshlrev_b32 v5, 1, v0
    v_sub_u32 v5, s36, v5
    s_mov_b32 s37, 0xffff0000
    v_subrev_u32 v6, 0, v5
    v_and_or_b32 v16, v16, s37, v6
    v_subrev_u32 v6, 1, v5
    v_and_or_b32 v18, v18, s37, v6
    v_subrev_u32 v6, 128, v5
    v_and_or_b32 v20, v20, s37, v6
    v_subrev_u32 v6, 129, v5
    v_and_or_b32 v22, v22, s37, v6
    v_subrev_u32 v6, 256, v5
    v_and_or_b32 v24, v24, s37, v6
    v_subrev_u32 v6, 257, v5
    v_and_or_b32 v26, v26, s37, v6
    v_subrev_u32 v6, 384, v5
    v_and_or_b32 v28, v28, s37, v6
    v_subrev_u32 v6, 385, v5
    v_and_or_b32 v30, v30, s37, v6
    s_mov_b32 s45, -1
    v_sub_u32 v32, s45, v16
    v_sub_u32 v33, s45, v18
    v_sub_u32 v34, s45, v20
    v_sub_u32 v35, s45, v22
    v_sub_u32 v36, s45, v24
    v_sub_u32 v37, s45, v26
    v_sub_u32 v38, s45, v28
    v_sub_u32 v39, s45, v30
    v_min3_u32 v5, v32, v33, v34
    v_min3_u32 v5, v5, v35, v36
    v_min3_u32 v5, v5, v37, v38
    v_min_u32 v5, v5, v39
    s_nop 1
    v_min_u32_dpp v5, v5, v5 row_shr:1 row_mask:0xf bank_mask:0xf
    s_nop 1
    v_min_u32_dpp v5, v5, v5 row_shr:2 row_mask:0xf bank_mask:0xf
    s_nop 1
    v_min_u32_dpp v5, v5, v5 row_shr:4 row_mask:0xf bank_mask:0xf
    s_nop 1
    v_min_u32_dpp v5, v5, v5 row_shr:8 row_mask:0xf bank_mask:0xf
    s_nop 1
    v_min_u32_dpp v5, v5, v5 row_bcast:15 row_mask:0xa bank_mask:0xf
    s_nop 1
    v_min_u32_dpp v5, v5, v5 row_bcast:31 row_mask:0xc bank_mask:0xf
    s_nop 0
    v_readlane_b32 s44, v5, 63
    s_nop 0
    s_sub_u32 s56, s45, s44
    s_sub_u32 s45, s56, 1
    v_sub_u32 v32, s45, v16
    v_sub_u32 v33, s45, v18
    v_sub_u32 v34, s45, v20
    v_sub_u32 v35, s45, v22
    v_sub_u32 v36, s45, v24
    v_sub_u32 v37, s45, v26
    v_sub_u32 v38, s45, v28
    v_sub_u32 v39, s45, v30
    v_min3_u32 v5, v32, v33, v34
    v_min3_u32 v5, v5, v35, v36
    v_min3_u32 v5, v5, v37, v38
    v_min_u32 v5, v5, v39
    s_nop 1
    v_min_u32_dpp v5, v5, v5 row_shr:1 row_mask:0xf bank_mask:0xf
    s_nop 1
    v_min_u32_dpp v5, v5, v5 row_shr:2 row_mask:0xf bank_mask:0xf
    s_nop 1
    v_min_u32_dpp v5, v5, v5 row_shr:4 row_mask:0xf bank_mask:0xf
    s_nop 1
    v_min_u32_dpp v5, v5, v5 row_shr:8 row_mask:0xf bank_mask:0xf
    s_nop 1
    v_min_u32_dpp v5, v5, v5 row_bcast:15 row_mask:0xa bank_mask:0xf
    s_nop 1
    v_min_u32_dpp v5, v5, v5 row_bcast:31 row_mask:0xc bank_mask:0xf
    s_nop 0
    v_readlane_b32 s44, v5, 63
    s_nop 0
    s_sub_u32 s57, s45, s44
    s_sub_u32 s45, s57, 1
    v_sub_u32 v32, s45, v16
    v_sub_u32 v33, s45, v18
    v_sub_u32 v34, s45, v20
    v_sub_u32 v35, s45, v22
    v_sub_u32 v36, s45, v24
    v_sub_u32 v37, s45, v26
    v_sub_u32 v38, s45, v28
    v_sub_u32 v39, s45, v30
    v_min3_u32 v5, v32, v33, v34
    v_min3_u32 v5, v5, v35, v36
    v_min3_u32 v5, v5, v37, v38
    v_min_u32 v5, v5, v39
    s_nop 1
    v_min_u32_dpp v5, v5, v5 row_shr:1 row_mask:0xf bank_mask:0xf
    s_nop 1
    v_min_u32_dpp v5, v5, v5 row_shr:2 row_mask:0xf bank_mask:0xf
    s_nop 1
    v_min_u32_dpp v5, v5, v5 row_shr:4 row_mask:0xf bank_mask:0xf
    s_nop 1
    v_min_u32_dpp v5, v5, v5 row_shr:8 row_mask:0xf bank_mask:0xf
    s_nop 1
    v_min_u32_dpp v5, v5, v5 row_bcast:15 row_mask:0xa bank_mask:0xf
    s_nop 1
    v_min_u32_dpp v5, v5, v5 row_bcast:31 row_mask:0xc bank_mask:0xf
    s_nop 0
    v_readlane_b32 s44, v5, 63
    s_nop 0
    s_sub_u32 s58, s45, s44
    s_sub_u32 s45, s58, 1
    v_sub_u32 v32, s45, v16
    v_sub_u32 v33, s45, v18
    v_sub_u32 v34, s45, v20
    v_sub_u32 v35, s45, v22
    v_sub_u32 v36, s45, v24
    v_sub_u32 v37, s45, v26
    v_sub_u32 v38, s45, v28
    v_sub_u32 v39, s45, v30
    v_min3_u32 v5, v32, v33, v34
    v_min3_u32 v5, v5, v35, v36
    v_min3_u32 v5, v5, v37, v38
    v_min_u32 v5, v5, v39
    s_nop 1
    v_min_u32_dpp v5, v5, v5 row_shr:1 row_mask:0xf bank_mask:0xf
    s_nop 1
    v_min_u32_dpp v5, v5, v5 row_shr:2 row_mask:0xf bank_mask:0xf
    s_nop 1
    v_min_u32_dpp v5, v5, v5 row_shr:4 row_mask:0xf bank_mask:0xf
    s_nop 1
    v_min_u32_dpp v5, v5, v5 row_shr:8 row_mask:0xf bank_mask:0xf
    s_nop 1
    v_min_u32_dpp v5, v5, v5 row_bcast:15 row_mask:0xa bank_mask:0xf
    s_nop 1
    v_min_u32_dpp v5, v5, v5 row_bcast:31 row_mask:0xc bank_mask:0xf
    s_nop 0
    v_readlane_b32 s44, v5, 63
    s_nop 0
    s_sub_u32 s59, s45, s44
    s_sub_u32 s45, s59, 1
    v_sub_u32 v32, s45, v16
    v_sub_u32 v33, s45, v18
    v_sub_u32 v34, s45, v20
    v_sub_u32 v35, s45, v22
    v_sub_u32 v36, s45, v24
    v_sub_u32 v37, s45, v26
    v_sub_u32 v38, s45, v28
    v_sub_u32 v39, s45, v30
    v_min3_u32 v5, v32, v33, v34
    v_min3_u32 v5, v5, v35, v36
    v_min3_u32 v5, v5, v37, v38
    v_min_u32 v5, v5, v39
    s_nop 1
    v_min_u32_dpp v5, v5, v5 row_shr:1 row_mask:0xf bank_mask:0xf
    s_nop 1
    v_min_u32_dpp v5, v5, v5 row_shr:2 row_mask:0xf bank_mask:0xf
    s_nop 1
    v_min_u32_dpp v5, v5, v5 row_shr:4 row_mask:0xf bank_mask:0xf
    s_nop 1
    v_min_u32_dpp v5, v5, v5 row_shr:8 row_mask:0xf bank_mask:0xf
    s_nop 1
    v_min_u32_dpp v5, v5, v5 row_bcast:15 row_mask:0xa bank_mask:0xf
    s_nop 1
    v_min_u32_dpp v5, v5, v5 row_bcast:31 row_mask:0xc bank_mask:0xf
    s_nop 0
    v_readlane_b32 s44, v5, 63
    s_nop 0
    s_sub_u32 s60, s45, s44
    s_sub_u32 s45, s60, 1
    v_sub_u32 v32, s45, v16
    v_sub_u32 v33, s45, v18
    v_sub_u32 v34, s45, v20
    v_sub_u32 v35, s45, v22
    v_sub_u32 v36, s45, v24
    v_sub_u32 v37, s45, v26
    v_sub_u32 v38, s45, v28
    v_sub_u32 v39, s45, v30
    v_min3_u32 v5, v32, v33, v34
    v_min3_u32 v5, v5, v35, v36
    v_min3_u32 v5, v5, v37, v38
    v_min_u32 v5, v5, v39
    s_nop 1
    v_min_u32_dpp v5, v5, v5 row_shr:1 row_mask:0xf bank_mask:0xf
    s_nop 1
    v_min_u32_dpp v5, v5, v5 row_shr:2 row_mask:0xf bank_mask:0xf
    s_nop 1
    v_min_u32_dpp v5, v5, v5 row_shr:4 row_mask:0xf bank_mask:0xf
    s_nop 1
    v_min_u32_dpp v5, v5, v5 row_shr:8 row_mask:0xf bank_mask:0xf
    s_nop 1
    v_min_u32_dpp v5, v5, v5 row_bcast:15 row_mask:0xa bank_mask:0xf
    s_nop 1
    v_min_u32_dpp v5, v5, v5 row_bcast:31 row_mask:0xc bank_mask:0xf
    s_nop 0
    v_readlane_b32 s44, v5, 63
    s_nop 0
    s_sub_u32 s61, s45, s44
    s_sub_u32 s45, s61, 1
    v_sub_u32 v32, s45, v16
    v_sub_u32 v33, s45, v18
    v_sub_u32 v34, s45, v20
    v_sub_u32 v35, s45, v22
    v_sub_u32 v36, s45, v24
    v_sub_u32 v37, s45, v26
    v_sub_u32 v38, s45, v28
    v_sub_u32 v39, s45, v30
    v_min3_u32 v5, v32, v33, v34
    v_min3_u32 v5, v5, v35, v36
    v_min3_u32 v5, v5, v37, v38
    v_min_u32 v5, v5, v39
    s_nop 1
    v_min_u32_dpp v5, v5, v5 row_shr:1 row_mask:0xf bank_mask:0xf
    s_nop 1
    v_min_u32_dpp v5, v5, v5 row_shr:2 row_mask:0xf bank_mask:0xf
    s_nop 1
    v_min_u32_dpp v5, v5, v5 row_shr:4 row_mask:0xf bank_mask:0xf
    s_nop 1
    v_min_u32_dpp v5, v5, v5 row_shr:8 row_mask:0xf bank_mask:0xf
    s_nop 1
    v_min_u32_dpp v5, v5, v5 row_bcast:15 row_mask:0xa bank_mask:0xf
    s_nop 1
    v_min_u32_dpp v5, v5, v5 row_bcast:31 row_mask:0xc bank_mask:0xf
    s_nop 0
    v_readlane_b32 s44, v5, 63
    s_nop 0
    s_sub_u32 s62, s45, s44
    s_sub_u32 s45, s62, 1
    v_sub_u32 v32, s45, v16
    v_sub_u32 v33, s45, v18
    v_sub_u32 v34, s45, v20
    v_sub_u32 v35, s45, v22
    v_sub_u32 v36, s45, v24
    v_sub_u32 v37, s45, v26
    v_sub_u32 v38, s45, v28
    v_sub_u32 v39, s45, v30
    v_min3_u32 v5, v32, v33, v34
    v_min3_u32 v5, v5, v35, v36
    v_min3_u32 v5, v5, v37, v38
    v_min_u32 v5, v5, v39
    s_nop 1
    v_min_u32_dpp v5, v5, v5 row_shr:1 row_mask:0xf bank_mask:0xf
    s_nop 1
    v_min_u32_dpp v5, v5, v5 row_shr:2 row_mask:0xf bank_mask:0xf
    s_nop 1
    v_min_u32_dpp v5, v5, v5 row_shr:4 row_mask:0xf bank_mask:0xf
    s_nop 1
    v_min_u32_dpp v5, v5, v5 row_shr:8 row_mask:0xf bank_mask:0xf
    s_nop 1
    v_min_u32_dpp v5, v5, v5 row_bcast:15 row_mask:0xa bank_mask:0xf
    s_nop 1
    v_min_u32_dpp v5, v5, v5 row_bcast:31 row_mask:0xc bank_mask:0xf
    s_nop 0
    v_readlane_b32 s44, v5, 63
    s_nop 0
    s_sub_u32 s63, s45, s44
    v_writelane_b32 v5, s56, 0
    v_writelane_b32 v5, s57, 1
    v_writelane_b32 v5, s58, 2
    v_writelane_b32 v5, s59, 3
    v_writelane_b32 v5, s60, 4
    v_writelane_b32 v5, s61, 5
    v_writelane_b32 v5, s62, 6
    v_writelane_b32 v5, s63, 7
    s_lshl_b32 s36, s30, 5
    v_lshlrev_b32 v6, 2, v0
    v_add3_u32 v4, v6, v1, s36
    s_mov_b64 exec, 0xff
    ds_write_b32 v4, v5 offset:160
    s_mov_b64 exec, -1
    s_waitcnt lgkmcnt(0)
    s_mov_b64 exec, 1
    ds_add_rtn_u32 v4, v1, v2 offset:52
    s_mov_b64 exec, -1
    s_waitcnt lgkmcnt(0)
    v_readfirstlane_b32 s47, v4
    s_nop 0
    s_cmp_lg_u32 s47, 3
    s_cbranch_scc1 M_WSEL
    v_and_b32 v6, 0x7c, v6
    v_add_u32 v4, v6, v1
    ds_read_b32 v6, v4 offset:160
    ds_read_b128 v[16:19], v1 offset:160
    ds_read_b128 v[20:23], v1 offset:176
    ds_read_b128 v[24:27], v1 offset:192
    ds_read_b128 v[28:31], v1 offset:208
    ds_read_b128 v[32:35], v1 offset:224
    ds_read_b128 v[36:39], v1 offset:240
    ds_read_b128 v[40:43], v1 offset:256
    ds_read_b128 v[44:47], v1 offset:272
    v_mov_b32 v4, 0
    s_waitcnt lgkmcnt(0)
    v_cmp_gt_u32 s[56:57], v16, v6
    v_cmp_gt_u32 s[58:59], v17, v6
    v_cmp_gt_u32 s[60:61], v18, v6
    v_cmp_gt_u32 s[62:63], v19, v6
    v_addc_co_u32 v4, vcc, 0, v4, s[56:57]
    v_addc_co_u32 v4, vcc, 0, v4, s[58:59]
    v_addc_co_u32 v4, vcc, 0, v4, s[60:61]
    v_addc_co_u32 v4, vcc, 0, v4, s[62:63]
    v_cmp_gt_u32 s[56:57], v20, v6
    v_cmp_gt_u32 s[58:59], v21, v6
    v_cmp_gt_u32 s[60:61], v22, v6
    v_cmp_gt_u32 s[62:63], v23, v6
    v_addc_co_u32 v4, vcc, 0, v4, s[56:57]
    v_addc_co_u32 v4, vcc, 0, v4, s[58:59]
    v_addc_co_u32 v4, vcc, 0, v4, s[60:61]
    v_addc_co_u32 v4, vcc, 0, v4, s[62:63]
    v_cmp_gt_u32 s[56:57], v24, v6
    v_cmp_gt_u32 s[58:59], v25, v6
    v_cmp_gt_u32 s[60:61], v26, v6
    v_cmp_gt_u32 s[62:63], v27, v6
    v_addc_co_u32 v4, vcc, 0, v4, s[56:57]
    v_addc_co_u32 v4, vcc, 0, v4, s[58:59]
    v_addc_co_u32 v4, vcc, 0, v4, s[60:61]
    v_addc_co_u32 v4, vcc, 0, v4, s[62:63]
    v_cmp_gt_u32 s[56:57], v28, v6
    v_cmp_gt_u32 s[58:59], v29, v6
    v_cmp_gt_u32 s[60:61], v30, v6
    v_cmp_gt_u32 s[62:63], v31, v6
    v_addc_co_u32 v4, vcc, 0, v4, s[56:57]
    v_addc_co_u32 v4, vcc, 0, v4, s[58:59]
    v_addc_co_u32 v4, vcc, 0, v4, s[60:61]
    v_addc_co_u32 v4, vcc, 0, v4, s[62:63]
    v_cmp_gt_u32 s[56:57], v32, v6
    v_cmp_gt_u32 s[58:59], v33, v6
    v_cmp_gt_u32 s[60:61], v34, v6
    v_cmp_gt_u32 s[62:63], v35, v6
    v_addc_co_u32 v4, vcc, 0, v4, s[56:57]
    v_addc_co_u32 v4, vcc, 0, v4, s[58:59]
    v_addc_co_u32 v4, vcc, 0, v4, s[60:61]
    v_addc_co_u32 v4, vcc, 0, v4, s[62:63]
    v_cmp_gt_u32 s[56:57], v36, v6
    v_cmp_gt_u32 s[58:59], v37, v6
    v_cmp_gt_u32 s[60:61], v38, v6
    v_cmp_gt_u32 s[62:63], v39, v6
    v_addc_co_u32 v4, vcc, 0, v4, s[56:57]
    v_addc_co_u32 v4, vcc, 0, v4, s[58:59]
    v_addc_co_u32 v4, vcc, 0, v4, s[60:61]
    v_addc_co_u32 v4, vcc, 0, v4, s[62:63]
    v_cmp_gt_u32 s[56:57], v40, v6
    v_cmp_gt_u32 s[58:59], v41, v6
    v_cmp_gt_u32 s[60:61], v42, v6
    v_cmp_gt_u32 s[62:63], v43, v6
    v_addc_co_u32 v4, vcc, 0, v4, s[56:57]
    v_addc_co_u32 v4, vcc, 0, v4, s[58:59]
    v_addc_co_u32 v4, vcc, 0, v4, s[60:61]
    v_addc_co_u32 v4, vcc, 0, v4, s[62:63]
    v_cmp_gt_u32 s[56:57], v44, v6
    v_cmp_gt_u32 s[58:59], v45, v6
    v_cmp_gt_u32 s[60:61], v46, v6
    v_cmp_gt_u32 s[62:63], v47, v6
    v_addc_co_u32 v4, vcc, 0, v4, s[56:57]
    v_addc_co_u32 v4, vcc, 0, v4, s[58:59]
    v_addc_co_u32 v4, vcc, 0, v4, s[60:61]
    v_addc_co_u32 v4, vcc, 0, v4, s[62:63]
    v_mov_b32 v7, s31
    v_cmp_gt_u32 vcc, 8, v4
    v_lshlrev_b32 v4, 3, v4
    s_mov_b32 s36, 8402944
    s_mov_b32 s37, 8388608
    s_mov_b32 exec_lo, vcc_lo
    s_mov_b32 exec_hi, 0
    buffer_store_dwordx2 v[6:7], v4, s[48:51], s36 offen sc1
    s_mov_b64 exec, 1
    buffer_store_dword v7, off, s[48:51], s37 sc1
    s_mov_b64 exec, -1
    s_mov_b64 exec, 1
    ds_add_u32 v1, v2 offset:76
    s_mov_b64 exec, -1
M_WSEL:
    s_mov_b32 s46, 16777216
LW_37:
    ds_read_b32 v4, v1 offset:76
    s_sub_u32 s46, s46, 1
    s_cbranch_scc1 LW_38
    s_waitcnt lgkmcnt(0)
    v_readfirstlane_b32 s47, v4
    s_nop 0
    s_cmp_ge_u32 s47, 1
    s_cbranch_scc1 LW_38
    s_sleep 2
    s_branch LW_37
LW_38:
M_NOSEL:
    s_setprio 0
    v_cndmask_b32 v42, v138, 0, s[64:65]
    v_cndmask_b32 v74, 0, v138, s[64:65]
    v_cndmask_b32 v43, v138, 0, s[66:67]
    v_cndmask_b32 v75, 0, v138, s[66:67]
    v_cndmask_b32 v44, v138, 0, s[68:69]
    v_cndmask_b32 v76, 0, v138, s[68:69]
    v_cndmask_b32 v45, v138, 0, s[70:71]
    v_cndmask_b32 v77, 0, v138, s[70:71]
    v_cndmask_b32 v46, v138, 0, s[72:73]
    v_cndmask_b32 v78, 0, v138, s[72:73]
    v_cndmask_b32 v47, v138, 0, s[74:75]
    v_cndmask_b32 v79, 0, v138, s[74:75]
    v_cndmask_b32 v48, v138, 0, s[76:77]
    v_cndmask_b32 v80, 0, v138, s[76:77]
    v_cndmask_b32 v49, v138, 0, s[78:79]
    v_cndmask_b32 v81, 0, v138, s[78:79]
    v_cndmask_b32 v50, v138, 0, s[80:81]
    v_cndmask_b32 v82, 0, v138, s[80:81]
    v_cndmask_b32 v51, v138, 0, s[82:83]
    v_cndmask_b32 v83, 0, v138, s[82:83]
    v_cndmask_b32 v52, v138, 0, s[84:85]
    v_cndmask_b32 v84, 0, v138, s[84:85]
    v_cndmask_b32 v53, v138, 0, s[86:87]
    v_cndmask_b32 v85, 0, v138, s[86:87]
    v_cndmask_b32 v54, v138, 0, s[88:89]
    v_cndmask_b32 v86, 0, v138, s[88:89]
    v_cndmask_b32 v55, v138, 0, s[90:91]
    v_cndmask_b32 v87, 0, v138, s[90:91]
    v_cndmask_b32 v56, v138, 0, s[92:93]
    v_cndmask_b32 v88, 0, v138, s[92:93]
    v_cndmask_b32 v57, v138, 0, s[94:95]
    v_cndmask_b32 v89, 0, v138, s[94:95]
    s_lshl_b32 s41, s29, 1
    s_add_u32 s41, s41, s28
    s_mov_b32 s60, s8
    s_mov_b32 s61, s9
    s_mov_b32 s62, 819200
    s_mov_b32 s63, 0x20000
    v_mul_u32_u24 v4, 26, v0
    v_lshrrev_b32 v4, 8, v4
    v_mul_u32_u24 v5, 10, v4
    v_sub_u32 v5, v0, v5
    v_mul_u32_u24 v4, 1280, v4
    v_lshl_add_u32 v4, v5, 4, v4
    s_lshr_b32 s37, s29, 2
    s_mul_i32 s37, s37, 160
    v_add_u32 v4, s37, v4
    s_mul_i32 s36, s30, 51200
    s_mul_i32 s37, s30, 6400
    s_mov_b32 exec_hi, 0x3ffff
    s_add_u32 s39, s41, 0
    s_and_b32 s39, s39, 3
    s_mul_i32 s40, s39, 204800
    s_add_u32 s40, s40, s36
    s_mul_i32 s39, s39, 25600
    s_add_u32 s39, s39, s37
    s_add_u32 m0, s39, 45248
    s_add_u32 s38, s40, 0
    buffer_load_dwordx4 v4, s[60:63], s38 offen lds
    s_add_u32 m0, s39, 46048
    s_add_u32 s38, s40, 6400
    buffer_load_dwordx4 v4, s[60:63], s38 offen lds
    s_add_u32 m0, s39, 46848
    s_add_u32 s38, s40, 12800
    buffer_load_dwordx4 v4, s[60:63], s38 offen lds
    s_add_u32 m0, s39, 47648
    s_add_u32 s38, s40, 19200
    buffer_load_dwordx4 v4, s[60:63], s38 offen lds
    s_add_u32 m0, s39, 48448
    s_add_u32 s38, s40, 25600
    buffer_load_dwordx4 v4, s[60:63], s38 offen lds
    s_add_u32 m0, s39, 49248
    s_add_u32 s38, s40, 32000
    buffer_load_dwordx4 v4, s[60:63], s38 offen lds
    s_add_u32 m0, s39, 50048
    s_add_u32 s38, s40, 38400
    buffer_load_dwordx4 v4, s[60:63], s38 offen lds
    s_add_u32 m0, s39, 50848
    s_add_u32 s38, s40, 44800
    buffer_load_dwordx4 v4, s[60:63], s38 offen lds
    s_add_u32 s39, s41, 1
    s_and_b32 s39, s39, 3
    s_mul_i32 s40, s39, 204800
    s_add_u32 s40, s40, s36
    s_mul_i32 s39, s39, 25600
    s_add_u32 s39, s39, s37
    s_add_u32 m0, s39, 45248
    s_add_u32 s38, s40, 0
    buffer_load_dwordx4 v4, s[60:63], s38 offen lds
    s_add_u32 m0, s39, 46048
    s_add_u32 s38, s40, 6400
    buffer_load_dwordx4 v4, s[60:63], s38 offen lds
    s_add_u32 m0, s39, 46848
    s_add_u32 s38, s40, 12800
    buffer_load_dwordx4 v4, s[60:63], s38 offen lds
    s_add_u32 m0, s39, 47648
    s_add_u32 s38, s40, 19200
    buffer_load_dwordx4 v4, s[60:63], s38 offen lds
    s_add_u32 m0, s39, 48448
    s_add_u32 s38, s40, 25600
    buffer_load_dwordx4 v4, s[60:63], s38 offen lds
    s_add_u32 m0, s39, 49248
    s_add_u32 s38, s40, 32000
    buffer_load_dwordx4 v4, s[60:63], s38 offen lds
    s_add_u32 m0, s39, 50048
    s_add_u32 s38, s40, 38400
    buffer_load_dwordx4 v4, s[60:63], s38 offen lds
    s_add_u32 m0, s39, 50848
    s_add_u32 s38, s40, 44800
    buffer_load_dwordx4 v4, s[60:63], s38 offen lds
    s_add_u32 s39, s41, 2
    s_and_b32 s39, s39, 3
    s_mul_i32 s40, s39, 204800
    s_add_u32 s40, s40, s36
    s_mul_i32 s39, s39, 25600
    s_add_u32 s39, s39, s37
    s_add_u32 m0, s39, 45248
    s_add_u32 s38, s40, 0
    buffer_load_dwordx4 v4, s[60:63], s38 offen lds
    s_add_u32 m0, s39, 46048
    s_add_u32 s38, s40, 6400
    buffer_load_dwordx4 v4, s[60:63], s38 offen lds
    s_add_u32 m0, s39, 46848
    s_add_u32 s38, s40, 12800
    buffer_load_dwordx4 v4, s[60:63], s38 offen lds
    s_add_u32 m0, s39, 47648
    s_add_u32 s38, s40, 19200
    buffer_load_dwordx4 v4, s[60:63], s38 offen lds
    s_add_u32 m0, s39, 48448
    s_add_u32 s38, s40, 25600
    buffer_load_dwordx4 v4, s[60:63], s38 offen lds
    s_add_u32 m0, s39, 49248
    s_add_u32 s38, s40, 32000
    buffer_load_dwordx4 v4, s[60:63], s38 offen lds
    s_add_u32 m0, s39, 50048
    s_add_u32 s38, s40, 38400
    buffer_load_dwordx4 v4, s[60:63], s38 offen lds
    s_add_u32 m0, s39, 50848
    s_add_u32 s38, s40, 44800
    buffer_load_dwordx4 v4, s[60:63], s38 offen lds
    s_add_u32 s39, s41, 3
    s_and_b32 s39, s39, 3
    s_mul_i32 s40, s39, 204800
    s_add_u32 s40, s40, s36
    s_mul_i32 s39, s39, 25600
    s_add_u32 s39, s39, s37
    s_add_u32 m0, s39, 45248
    s_add_u32 s38, s40, 0
    buffer_load_dwordx4 v4, s[60:63], s38 offen lds
    s_add_u32 m0, s39, 46048
    s_add_u32 s38, s40, 6400
    buffer_load_dwordx4 v4, s[60:63], s38 offen lds
    s_add_u32 m0, s39, 46848
    s_add_u32 s38, s40, 12800
    buffer_load_dwordx4 v4, s[60:63], s38 offen lds
    s_add_u32 m0, s39, 47648
    s_add_u32 s38, s40, 19200
    buffer_load_dwordx4 v4, s[60:63], s38 offen lds
    s_add_u32 m0, s39, 48448
    s_add_u32 s38, s40, 25600
    buffer_load_dwordx4 v4, s[60:63], s38 offen lds
    s_add_u32 m0, s39, 49248
    s_add_u32 s38, s40, 32000
    buffer_load_dwordx4 v4, s[60:63], s38 offen lds
    s_add_u32 m0, s39, 50048
    s_add_u32 s38, s40, 38400
    buffer_load_dwordx4 v4, s[60:63], s38 offen lds
    s_add_u32 m0, s39, 50848
    s_add_u32 s38, s40, 44800
    buffer_load_dwordx4 v4, s[60:63], s38 offen lds
    s_lshl_b32 s36, s28, 2
    s_and_b32 s37, s29, 3
    s_add_u32 s36, s36, s37
    s_lshl_b32 s36, s36, 6
    s_lshl_b32 s37, s30, 4
    s_add_u32 s36, s36, s37
    s_mul_i32 s36, s36, 1280
    s_mul_i32 s37, s30, 2560
    s_mov_b32 exec_hi, 0xff
    s_add_u32 m0, s37, 147648
    s_add_u32 s38, s36, 0
    buffer_load_dwordx4 v4, s[52:55], s38 offen lds
    s_add_u32 m0, s37, 148288
    s_add_u32 s38, s36, 5120
    buffer_load_dwordx4 v4, s[52:55], s38 offen lds
    s_add_u32 m0, s37, 148928
    s_add_u32 s38, s36, 10240
    buffer_load_dwordx4 v4, s[52:55], s38 offen lds
    s_add_u32 m0, s37, 149568
    s_add_u32 s38, s36, 15360
    buffer_load_dwordx4 v4, s[52:55], s38 offen lds
    s_mov_b64 exec, -1
    s_waitcnt vmcnt(0)
    s_mov_b64 exec, 1
    ds_add_u32 v1, v2 offset:24
    s_mov_b64 exec, -1
    s_mov_b32 s46, 16777216
LW_39:
    ds_read_b32 v4, v1 offset:64
    s_sub_u32 s46, s46, 1
    s_cbranch_scc1 LW_40
    s_waitcnt lgkmcnt(0)
    v_readfirstlane_b32 s47, v4
    s_nop 0
    s_cmp_ge_u32 s47, 1
    s_cbranch_scc1 LW_40
    s_sleep 4
    s_branch LW_39
LW_40:
    s_branch P2_WQ
RC_GEMM:
    s_and_b32 s35, s30, 1
    s_lshr_b32 s36, s30, 1
    v_and_b32 v165, 15, v0
    v_lshrrev_b32 v166, 4, v0
    v_bfe_u32 v167, v0, 1, 3
    v_xor_b32 v167, v167, v166
    v_lshlrev_b32 v167, 4, v167
    v_lshl_add_u32 v152, v165, 7, v167
    s_lshl_b32 s37, s35, 13
    v_add_u32 v152, s37, v152
    v_xor_b32 v153, 64, v152
    v_add_u32 v154, 0x10000, v152
    v_add_u32 v155, 0x10000, v153
    v_bfe_u32 v167, v0, 2, 2
    v_lshl_add_u32 v156, v166, 3, v167
    v_lshlrev_b32 v156, 8, v156
    v_bfe_u32 v167, v0, 2, 3
    s_lshl_b32 s37, s36, 2
    v_xor_b32 v167, s37, v167
    v_lshl_add_u32 v156, v167, 5, v156
    v_and_b32 v167, 3, v0
    v_lshl_add_u32 v156, v167, 3, v156
    v_add_u32 v156, 16384, v156
    v_xor_b32 v157, 32, v156
    v_xor_b32 v158, 64, v156
    v_xor_b32 v159, 96, v156
    v_add_u32 v160, 0x10000, v156
    v_add_u32 v161, 0x10000, v157
    v_add_u32 v162, 0x10000, v158
    v_add_u32 v163, 0x10000, v159
    v_mul_u32_u24 v164, 16640, v166
    v_lshl_add_u32 v164, v165, 4, v164
    s_lshl_b32 s37, s32, 10
    s_lshl_b32 s38, s35, 9
    s_add_u32 s37, s37, s38
    v_add_u32 v164, s37, v164
    s_lshl_b32 s38, s33, 1
    s_add_u32 s38, s38, s36
    s_mul_i32 s38, s38, 266240
    s_lshl_b32 s36, s32, 4
    s_add_u32 s36, s36, s33
    s_lshl_b32 s37, s36, 7
    s_add_u32 s37, s37, 8421376
    s_mov_b32 s42, 0x3ea52b5c
    s_mov_b32 s43, s42
    s_barrier
    ds_read_b64_tr_b16 v[84:85], v156 offset:0
    ds_read_b64_tr_b16 v[86:87], v156 offset:1024
    ds_read_b128 v[68:71], v152 offset:0
    ds_read_b128 v[72:75], v152 offset:2048
    ds_read_b128 v[76:79], v152 offset:4096
    ds_read_b128 v[80:83], v152 offset:6144
    ds_read_b64_tr_b16 v[88:89], v157 offset:0
    ds_read_b64_tr_b16 v[90:91], v157 offset:1024
    ds_read_b64_tr_b16 v[92:93], v158 offset:0
    ds_read_b64_tr_b16 v[94:95], v158 offset:1024
    ds_read_b64_tr_b16 v[96:97], v159 offset:0
    ds_read_b64_tr_b16 v[98:99], v159 offset:1024
    s_waitcnt lgkmcnt(6)
    v_mfma_f32_16x16x32_bf16 v[4:7], v[84:87], v[68:71], 0
    ds_read_b64_tr_b16 v[116:117], v156 offset:8192
    v_mfma_f32_16x16x32_bf16 v[8:11], v[84:87], v[72:75], 0
    ds_read_b64_tr_b16 v[118:119], v156 offset:9216
    v_mfma_f32_16x16x32_bf16 v[12:15], v[84:87], v[76:79], 0
    ds_read_b128 v[100:103], v153 offset:0
    v_mfma_f32_16x16x32_bf16 v[16:19], v[84:87], v[80:83], 0
    ds_read_b128 v[104:107], v153 offset:2048
    s_waitcnt lgkmcnt(8)
    v_mfma_f32_16x16x32_bf16 v[20:23], v[88:91], v[68:71], 0
    ds_read_b128 v[108:111], v153 offset:4096
    v_mfma_f32_16x16x32_bf16 v[24:27], v[88:91], v[72:75], 0
    ds_read_b128 v[112:115], v153 offset:6144
    v_mfma_f32_16x16x32_bf16 v[28:31], v[88:91], v[76:79], 0
    ds_read_b64_tr_b16 v[120:121], v157 offset:8192
    v_mfma_f32_16x16x32_bf16 v[32:35], v[88:91], v[80:83], 0
    ds_read_b64_tr_b16 v[122:123], v157 offset:9216
    s_waitcnt lgkmcnt(10)
    v_mfma_f32_16x16x32_bf16 v[36:39], v[92:95], v[68:71], 0
    ds_read_b64_tr_b16 v[124:125], v158 offset:8192
    v_mfma_f32_16x16x32_bf16 v[40:43], v[92:95], v[72:75], 0
    ds_read_b64_tr_b16 v[126:127], v158 offset:9216
    v_mfma_f32_16x16x32_bf16 v[44:47], v[92:95], v[76:79], 0
    ds_read_b64_tr_b16 v[128:129], v159 offset:8192
    v_mfma_f32_16x16x32_bf16 v[48:51], v[92:95], v[80:83], 0
    ds_read_b64_tr_b16 v[130:131], v159 offset:9216
    s_waitcnt lgkmcnt(12)
    v_mfma_f32_16x16x32_bf16 v[52:55], v[96:99], v[68:71], 0
    v_mfma_f32_16x16x32_bf16 v[56:59], v[96:99], v[72:75], 0
    v_mfma_f32_16x16x32_bf16 v[60:63], v[96:99], v[76:79], 0
    v_mfma_f32_16x16x32_bf16 v[64:67], v[96:99], v[80:83], 0
    s_waitcnt lgkmcnt(6)
    v_mfma_f32_16x16x32_bf16 v[4:7], v[116:119], v[100:103], v[4:7]
    s_waitcnt lgkmcnt(0)
    s_barrier
    ds_read_b64_tr_b16 v[84:85], v156 offset:32768
    v_mfma_f32_16x16x32_bf16 v[8:11], v[116:119], v[104:107], v[8:11]
    ds_read_b64_tr_b16 v[86:87], v156 offset:33792
    v_mfma_f32_16x16x32_bf16 v[12:15], v[116:119], v[108:111], v[12:15]
    ds_read_b128 v[68:71], v152 offset:32768
    v_mfma_f32_16x16x32_bf16 v[16:19], v[116:119], v[112:115], v[16:19]
    ds_read_b128 v[72:75], v152 offset:34816
    s_waitcnt lgkmcnt(8)
    v_mfma_f32_16x16x32_bf16 v[20:23], v[120:123], v[100:103], v[20:23]
    ds_read_b128 v[76:79], v152 offset:36864
    v_mfma_f32_16x16x32_bf16 v[24:27], v[120:123], v[104:107], v[24:27]
    ds_read_b128 v[80:83], v152 offset:38912
    v_mfma_f32_16x16x32_bf16 v[28:31], v[120:123], v[108:111], v[28:31]
    ds_read_b64_tr_b16 v[88:89], v157 offset:32768
    v_mfma_f32_16x16x32_bf16 v[32:35], v[120:123], v[112:115], v[32:35]
    ds_read_b64_tr_b16 v[90:91], v157 offset:33792
    s_waitcnt lgkmcnt(10)
    v_mfma_f32_16x16x32_bf16 v[36:39], v[124:127], v[100:103], v[36:39]
    ds_read_b64_tr_b16 v[92:93], v158 offset:32768
    v_mfma_f32_16x16x32_bf16 v[40:43], v[124:127], v[104:107], v[40:43]
    ds_read_b64_tr_b16 v[94:95], v158 offset:33792
    v_mfma_f32_16x16x32_bf16 v[44:47], v[124:127], v[108:111], v[44:47]
    ds_read_b64_tr_b16 v[96:97], v159 offset:32768
    v_mfma_f32_16x16x32_bf16 v[48:51], v[124:127], v[112:115], v[48:51]
    ds_read_b64_tr_b16 v[98:99], v159 offset:33792
    s_waitcnt lgkmcnt(12)
    v_mfma_f32_16x16x32_bf16 v[52:55], v[128:131], v[100:103], v[52:55]
    v_mfma_f32_16x16x32_bf16 v[56:59], v[128:131], v[104:107], v[56:59]
    v_mfma_f32_16x16x32_bf16 v[60:63], v[128:131], v[108:111], v[60:63]
    v_mfma_f32_16x16x32_bf16 v[64:67], v[128:131], v[112:115], v[64:67]
    s_waitcnt lgkmcnt(6)
    v_mfma_f32_16x16x32_bf16 v[4:7], v[84:87], v[68:71], v[4:7]
    ds_read_b64_tr_b16 v[116:117], v156 offset:40960
    v_mfma_f32_16x16x32_bf16 v[8:11], v[84:87], v[72:75], v[8:11]
    ds_read_b64_tr_b16 v[118:119], v156 offset:41984
    v_mfma_f32_16x16x32_bf16 v[12:15], v[84:87], v[76:79], v[12:15]
    ds_read_b128 v[100:103], v153 offset:32768
    v_mfma_f32_16x16x32_bf16 v[16:19], v[84:87], v[80:83], v[16:19]
    ds_read_b128 v[104:107], v153 offset:34816
    s_waitcnt lgkmcnt(8)
    v_mfma_f32_16x16x32_bf16 v[20:23], v[88:91], v[68:71], v[20:23]
    ds_read_b128 v[108:111], v153 offset:36864
    v_mfma_f32_16x16x32_bf16 v[24:27], v[88:91], v[72:75], v[24:27]
    ds_read_b128 v[112:115], v153 offset:38912
    v_mfma_f32_16x16x32_bf16 v[28:31], v[88:91], v[76:79], v[28:31]
    ds_read_b64_tr_b16 v[120:121], v157 offset:40960
    v_mfma_f32_16x16x32_bf16 v[32:35], v[88:91], v[80:83], v[32:35]
    ds_read_b64_tr_b16 v[122:123], v157 offset:41984
    s_waitcnt lgkmcnt(10)
    v_mfma_f32_16x16x32_bf16 v[36:39], v[92:95], v[68:71], v[36:39]
    ds_read_b64_tr_b16 v[124:125], v158 offset:40960
    v_mfma_f32_16x16x32_bf16 v[40:43], v[92:95], v[72:75], v[40:43]
    ds_read_b64_tr_b16 v[126:127], v158 offset:41984
    v_mfma_f32_16x16x32_bf16 v[44:47], v[92:95], v[76:79], v[44:47]
    ds_read_b64_tr_b16 v[128:129], v159 offset:40960
    v_mfma_f32_16x16x32_bf16 v[48:51], v[92:95], v[80:83], v[48:51]
    ds_read_b64_tr_b16 v[130:131], v159 offset:41984
    s_waitcnt lgkmcnt(12)
    v_mfma_f32_16x16x32_bf16 v[52:55], v[96:99], v[68:71], v[52:55]
    v_mfma_f32_16x16x32_bf16 v[56:59], v[96:99], v[72:75], v[56:59]
    v_mfma_f32_16x16x32_bf16 v[60:63], v[96:99], v[76:79], v[60:63]
    v_mfma_f32_16x16x32_bf16 v[64:67], v[96:99], v[80:83], v[64:67]
    s_waitcnt lgkmcnt(6)
    v_mfma_f32_16x16x32_bf16 v[4:7], v[116:119], v[100:103], v[4:7]
    s_waitcnt lgkmcnt(0)
    s_barrier
    ds_read_b64_tr_b16 v[84:85], v160 offset:0
    v_mfma_f32_16x16x32_bf16 v[8:11], v[116:119], v[104:107], v[8:11]
    ds_read_b64_tr_b16 v[86:87], v160 offset:1024
    v_mfma_f32_16x16x32_bf16 v[12:15], v[116:119], v[108:111], v[12:15]
    ds_read_b128 v[68:71], v154 offset:0
    v_mfma_f32_16x16x32_bf16 v[16:19], v[116:119], v[112:115], v[16:19]
    ds_read_b128 v[72:75], v154 offset:2048
    s_waitcnt lgkmcnt(8)
    v_mfma_f32_16x16x32_bf16 v[20:23], v[120:123], v[100:103], v[20:23]
    ds_read_b128 v[76:79], v154 offset:4096
    v_mfma_f32_16x16x32_bf16 v[24:27], v[120:123], v[104:107], v[24:27]
    ds_read_b128 v[80:83], v154 offset:6144
    v_mfma_f32_16x16x32_bf16 v[28:31], v[120:123], v[108:111], v[28:31]
    ds_read_b64_tr_b16 v[88:89], v161 offset:0
    v_mfma_f32_16x16x32_bf16 v[32:35], v[120:123], v[112:115], v[32:35]
    ds_read_b64_tr_b16 v[90:91], v161 offset:1024
    s_waitcnt lgkmcnt(10)
    v_mfma_f32_16x16x32_bf16 v[36:39], v[124:127], v[100:103], v[36:39]
    ds_read_b64_tr_b16 v[92:93], v162 offset:0
    v_mfma_f32_16x16x32_bf16 v[40:43], v[124:127], v[104:107], v[40:43]
    ds_read_b64_tr_b16 v[94:95], v162 offset:1024
    v_mfma_f32_16x16x32_bf16 v[44:47], v[124:127], v[108:111], v[44:47]
    ds_read_b64_tr_b16 v[96:97], v163 offset:0
    v_mfma_f32_16x16x32_bf16 v[48:51], v[124:127], v[112:115], v[48:51]
    ds_read_b64_tr_b16 v[98:99], v163 offset:1024
    s_waitcnt lgkmcnt(12)
    v_mfma_f32_16x16x32_bf16 v[52:55], v[128:131], v[100:103], v[52:55]
    v_mfma_f32_16x16x32_bf16 v[56:59], v[128:131], v[104:107], v[56:59]
    v_mfma_f32_16x16x32_bf16 v[60:63], v[128:131], v[108:111], v[60:63]
    v_mfma_f32_16x16x32_bf16 v[64:67], v[128:131], v[112:115], v[64:67]
    s_waitcnt lgkmcnt(6)
    v_mfma_f32_16x16x32_bf16 v[4:7], v[84:87], v[68:71], v[4:7]
    ds_read_b64_tr_b16 v[116:117], v160 offset:8192
    v_mfma_f32_16x16x32_bf16 v[8:11], v[84:87], v[72:75], v[8:11]
    ds_read_b64_tr_b16 v[118:119], v160 offset:9216
    v_mfma_f32_16x16x32_bf16 v[12:15], v[84:87], v[76:79], v[12:15]
    ds_read_b128 v[100:103], v155 offset:0
    v_mfma_f32_16x16x32_bf16 v[16:19], v[84:87], v[80:83], v[16:19]
    ds_read_b128 v[104:107], v155 offset:2048
    s_waitcnt lgkmcnt(8)
    v_mfma_f32_16x16x32_bf16 v[20:23], v[88:91], v[68:71], v[20:23]
    ds_read_b128 v[108:111], v155 offset:4096
    v_mfma_f32_16x16x32_bf16 v[24:27], v[88:91], v[72:75], v[24:27]
    ds_read_b128 v[112:115], v155 offset:6144
    v_mfma_f32_16x16x32_bf16 v[28:31], v[88:91], v[76:79], v[28:31]
    ds_read_b64_tr_b16 v[120:121], v161 offset:8192
    v_mfma_f32_16x16x32_bf16 v[32:35], v[88:91], v[80:83], v[32:35]
    ds_read_b64_tr_b16 v[122:123], v161 offset:9216
    s_waitcnt lgkmcnt(10)
    v_mfma_f32_16x16x32_bf16 v[36:39], v[92:95], v[68:71], v[36:39]
    ds_read_b64_tr_b16 v[124:125], v162 offset:8192
    v_mfma_f32_16x16x32_bf16 v[40:43], v[92:95], v[72:75], v[40:43]
    ds_read_b64_tr_b16 v[126:127], v162 offset:9216
    v_mfma_f32_16x16x32_bf16 v[44:47], v[92:95], v[76:79], v[44:47]
    ds_read_b64_tr_b16 v[128:129], v163 offset:8192
    v_mfma_f32_16x16x32_bf16 v[48:51], v[92:95], v[80:83], v[48:51]
    ds_read_b64_tr_b16 v[130:131], v163 offset:9216
    s_waitcnt lgkmcnt(12)
    v_mfma_f32_16x16x32_bf16 v[52:55], v[96:99], v[68:71], v[52:55]
    v_mfma_f32_16x16x32_bf16 v[56:59], v[96:99], v[72:75], v[56:59]
    v_mfma_f32_16x16x32_bf16 v[60:63], v[96:99], v[76:79], v[60:63]
    v_mfma_f32_16x16x32_bf16 v[64:67], v[96:99], v[80:83], v[64:67]
    s_waitcnt lgkmcnt(6)
    v_mfma_f32_16x16x32_bf16 v[4:7], v[116:119], v[100:103], v[4:7]
    s_waitcnt lgkmcnt(0)
    s_barrier
    ds_read_b64_tr_b16 v[84:85], v160 offset:32768
    v_mfma_f32_16x16x32_bf16 v[8:11], v[116:119], v[104:107], v[8:11]
    ds_read_b64_tr_b16 v[86:87], v160 offset:33792
    v_mfma_f32_16x16x32_bf16 v[12:15], v[116:119], v[108:111], v[12:15]
    ds_read_b128 v[68:71], v154 offset:32768
    v_mfma_f32_16x16x32_bf16 v[16:19], v[116:119], v[112:115], v[16:19]
    ds_read_b128 v[72:75], v154 offset:34816
    s_waitcnt lgkmcnt(8)
    v_mfma_f32_16x16x32_bf16 v[20:23], v[120:123], v[100:103], v[20:23]
    ds_read_b128 v[76:79], v154 offset:36864
    v_mfma_f32_16x16x32_bf16 v[24:27], v[120:123], v[104:107], v[24:27]
    ds_read_b128 v[80:83], v154 offset:38912
    v_mfma_f32_16x16x32_bf16 v[28:31], v[120:123], v[108:111], v[28:31]
    ds_read_b64_tr_b16 v[88:89], v161 offset:32768
    v_mfma_f32_16x16x32_bf16 v[32:35], v[120:123], v[112:115], v[32:35]
    ds_read_b64_tr_b16 v[90:91], v161 offset:33792
    s_waitcnt lgkmcnt(10)
    v_mfma_f32_16x16x32_bf16 v[36:39], v[124:127], v[100:103], v[36:39]
    ds_read_b64_tr_b16 v[92:93], v162 offset:32768
    v_mfma_f32_16x16x32_bf16 v[40:43], v[124:127], v[104:107], v[40:43]
    ds_read_b64_tr_b16 v[94:95], v162 offset:33792
    v_mfma_f32_16x16x32_bf16 v[44:47], v[124:127], v[108:111], v[44:47]
    ds_read_b64_tr_b16 v[96:97], v163 offset:32768
    v_mfma_f32_16x16x32_bf16 v[48:51], v[124:127], v[112:115], v[48:51]
    ds_read_b64_tr_b16 v[98:99], v163 offset:33792
    s_waitcnt lgkmcnt(12)
    v_mfma_f32_16x16x32_bf16 v[52:55], v[128:131], v[100:103], v[52:55]
    v_mfma_f32_16x16x32_bf16 v[56:59], v[128:131], v[104:107], v[56:59]
    v_mfma_f32_16x16x32_bf16 v[60:63], v[128:131], v[108:111], v[60:63]
    v_mfma_f32_16x16x32_bf16 v[64:67], v[128:131], v[112:115], v[64:67]
    s_waitcnt lgkmcnt(6)
    v_mfma_f32_16x16x32_bf16 v[4:7], v[84:87], v[68:71], v[4:7]
    ds_read_b64_tr_b16 v[116:117], v160 offset:40960
    v_mfma_f32_16x16x32_bf16 v[8:11], v[84:87], v[72:75], v[8:11]
    ds_read_b64_tr_b16 v[118:119], v160 offset:41984
    v_mfma_f32_16x16x32_bf16 v[12:15], v[84:87], v[76:79], v[12:15]
    ds_read_b128 v[100:103], v155 offset:32768
    v_mfma_f32_16x16x32_bf16 v[16:19], v[84:87], v[80:83], v[16:19]
    ds_read_b128 v[104:107], v155 offset:34816
    s_waitcnt lgkmcnt(8)
    v_mfma_f32_16x16x32_bf16 v[20:23], v[88:91], v[68:71], v[20:23]
    ds_read_b128 v[108:111], v155 offset:36864
    v_mfma_f32_16x16x32_bf16 v[24:27], v[88:91], v[72:75], v[24:27]
    ds_read_b128 v[112:115], v155 offset:38912
    v_mfma_f32_16x16x32_bf16 v[28:31], v[88:91], v[76:79], v[28:31]
    ds_read_b64_tr_b16 v[120:121], v161 offset:40960
    v_mfma_f32_16x16x32_bf16 v[32:35], v[88:91], v[80:83], v[32:35]
    ds_read_b64_tr_b16 v[122:123], v161 offset:41984
    s_waitcnt lgkmcnt(10)
    v_mfma_f32_16x16x32_bf16 v[36:39], v[92:95], v[68:71], v[36:39]
    ds_read_b64_tr_b16 v[124:125], v162 offset:40960
    v_mfma_f32_16x16x32_bf16 v[40:43], v[92:95], v[72:75], v[40:43]
    ds_read_b64_tr_b16 v[126:127], v162 offset:41984
    v_mfma_f32_16x16x32_bf16 v[44:47], v[92:95], v[76:79], v[44:47]
    ds_read_b64_tr_b16 v[128:129], v163 offset:40960
    v_mfma_f32_16x16x32_bf16 v[48:51], v[92:95], v[80:83], v[48:51]
    ds_read_b64_tr_b16 v[130:131], v163 offset:41984
    s_waitcnt lgkmcnt(12)
    v_mfma_f32_16x16x32_bf16 v[52:55], v[96:99], v[68:71], v[52:55]
    v_mfma_f32_16x16x32_bf16 v[56:59], v[96:99], v[72:75], v[56:59]
    v_mfma_f32_16x16x32_bf16 v[60:63], v[96:99], v[76:79], v[60:63]
    v_mfma_f32_16x16x32_bf16 v[64:67], v[96:99], v[80:83], v[64:67]
    s_waitcnt lgkmcnt(6)
    v_mfma_f32_16x16x32_bf16 v[4:7], v[116:119], v[100:103], v[4:7]
    s_waitcnt lgkmcnt(0)
    s_barrier
    ds_read_b64_tr_b16 v[84:85], v156 offset:0
    v_mfma_f32_16x16x32_bf16 v[8:11], v[116:119], v[104:107], v[8:11]
    ds_read_b64_tr_b16 v[86:87], v156 offset:1024
    v_mfma_f32_16x16x32_bf16 v[12:15], v[116:119], v[108:111], v[12:15]
    ds_read_b128 v[68:71], v152 offset:0
    v_mfma_f32_16x16x32_bf16 v[16:19], v[116:119], v[112:115], v[16:19]
    ds_read_b128 v[72:75], v152 offset:2048
    s_waitcnt lgkmcnt(8)
    v_mfma_f32_16x16x32_bf16 v[20:23], v[120:123], v[100:103], v[20:23]
    ds_read_b128 v[76:79], v152 offset:4096
    v_mfma_f32_16x16x32_bf16 v[24:27], v[120:123], v[104:107], v[24:27]
    ds_read_b128 v[80:83], v152 offset:6144
    v_mfma_f32_16x16x32_bf16 v[28:31], v[120:123], v[108:111], v[28:31]
    ds_read_b64_tr_b16 v[88:89], v157 offset:0
    v_mfma_f32_16x16x32_bf16 v[32:35], v[120:123], v[112:115], v[32:35]
    ds_read_b64_tr_b16 v[90:91], v157 offset:1024
    s_waitcnt lgkmcnt(10)
    v_mfma_f32_16x16x32_bf16 v[36:39], v[124:127], v[100:103], v[36:39]
    ds_read_b64_tr_b16 v[92:93], v158 offset:0
    v_mfma_f32_16x16x32_bf16 v[40:43], v[124:127], v[104:107], v[40:43]
    ds_read_b64_tr_b16 v[94:95], v158 offset:1024
    v_mfma_f32_16x16x32_bf16 v[44:47], v[124:127], v[108:111], v[44:47]
    ds_read_b64_tr_b16 v[96:97], v159 offset:0
    v_mfma_f32_16x16x32_bf16 v[48:51], v[124:127], v[112:115], v[48:51]
    ds_read_b64_tr_b16 v[98:99], v159 offset:1024
    s_waitcnt lgkmcnt(12)
    v_mfma_f32_16x16x32_bf16 v[52:55], v[128:131], v[100:103], v[52:55]
    v_mfma_f32_16x16x32_bf16 v[56:59], v[128:131], v[104:107], v[56:59]
    v_mfma_f32_16x16x32_bf16 v[60:63], v[128:131], v[108:111], v[60:63]
    v_mfma_f32_16x16x32_bf16 v[64:67], v[128:131], v[112:115], v[64:67]
    s_waitcnt lgkmcnt(6)
    v_mfma_f32_16x16x32_bf16 v[4:7], v[84:87], v[68:71], v[4:7]
    ds_read_b64_tr_b16 v[116:117], v156 offset:8192
    v_mfma_f32_16x16x32_bf16 v[8:11], v[84:87], v[72:75], v[8:11]
    ds_read_b64_tr_b16 v[118:119], v156 offset:9216
    v_mfma_f32_16x16x32_bf16 v[12:15], v[84:87], v[76:79], v[12:15]
    ds_read_b128 v[100:103], v153 offset:0
    v_mfma_f32_16x16x32_bf16 v[16:19], v[84:87], v[80:83], v[16:19]
    ds_read_b128 v[104:107], v153 offset:2048
    s_waitcnt lgkmcnt(8)
    v_mfma_f32_16x16x32_bf16 v[20:23], v[88:91], v[68:71], v[20:23]
    ds_read_b128 v[108:111], v153 offset:4096
    v_mfma_f32_16x16x32_bf16 v[24:27], v[88:91], v[72:75], v[24:27]
    ds_read_b128 v[112:115], v153 offset:6144
    v_mfma_f32_16x16x32_bf16 v[28:31], v[88:91], v[76:79], v[28:31]
    ds_read_b64_tr_b16 v[120:121], v157 offset:8192
    v_mfma_f32_16x16x32_bf16 v[32:35], v[88:91], v[80:83], v[32:35]
    ds_read_b64_tr_b16 v[122:123], v157 offset:9216
    s_waitcnt lgkmcnt(10)
    v_mfma_f32_16x16x32_bf16 v[36:39], v[92:95], v[68:71], v[36:39]
    ds_read_b64_tr_b16 v[124:125], v158 offset:8192
    v_mfma_f32_16x16x32_bf16 v[40:43], v[92:95], v[72:75], v[40:43]
    ds_read_b64_tr_b16 v[126:127], v158 offset:9216
    v_mfma_f32_16x16x32_bf16 v[44:47], v[92:95], v[76:79], v[44:47]
    ds_read_b64_tr_b16 v[128:129], v159 offset:8192
    v_mfma_f32_16x16x32_bf16 v[48:51], v[92:95], v[80:83], v[48:51]
    ds_read_b64_tr_b16 v[130:131], v159 offset:9216
    s_waitcnt lgkmcnt(12)
    v_mfma_f32_16x16x32_bf16 v[52:55], v[96:99], v[68:71], v[52:55]
    v_mfma_f32_16x16x32_bf16 v[56:59], v[96:99], v[72:75], v[56:59]
    v_mfma_f32_16x16x32_bf16 v[60:63], v[96:99], v[76:79], v[60:63]
    v_mfma_f32_16x16x32_bf16 v[64:67], v[96:99], v[80:83], v[64:67]
    s_waitcnt lgkmcnt(6)
    v_mfma_f32_16x16x32_bf16 v[4:7], v[116:119], v[100:103], v[4:7]
    s_waitcnt lgkmcnt(0)
    s_barrier
    ds_read_b64_tr_b16 v[84:85], v156 offset:32768
    v_mfma_f32_16x16x32_bf16 v[8:11], v[116:119], v[104:107], v[8:11]
    ds_read_b64_tr_b16 v[86:87], v156 offset:33792
    v_mfma_f32_16x16x32_bf16 v[12:15], v[116:119], v[108:111], v[12:15]
    ds_read_b128 v[68:71], v152 offset:32768
    v_mfma_f32_16x16x32_bf16 v[16:19], v[116:119], v[112:115], v[16:19]
    ds_read_b128 v[72:75], v152 offset:34816
    s_waitcnt lgkmcnt(8)
    v_mfma_f32_16x16x32_bf16 v[20:23], v[120:123], v[100:103], v[20:23]
    ds_read_b128 v[76:79], v152 offset:36864
    v_mfma_f32_16x16x32_bf16 v[24:27], v[120:123], v[104:107], v[24:27]
    ds_read_b128 v[80:83], v152 offset:38912
    v_mfma_f32_16x16x32_bf16 v[28:31], v[120:123], v[108:111], v[28:31]
    ds_read_b64_tr_b16 v[88:89], v157 offset:32768
    v_mfma_f32_16x16x32_bf16 v[32:35], v[120:123], v[112:115], v[32:35]
    ds_read_b64_tr_b16 v[90:91], v157 offset:33792
    s_waitcnt lgkmcnt(10)
    v_mfma_f32_16x16x32_bf16 v[36:39], v[124:127], v[100:103], v[36:39]
    ds_read_b64_tr_b16 v[92:93], v158 offset:32768
    v_mfma_f32_16x16x32_bf16 v[40:43], v[124:127], v[104:107], v[40:43]
    ds_read_b64_tr_b16 v[94:95], v158 offset:33792
    v_mfma_f32_16x16x32_bf16 v[44:47], v[124:127], v[108:111], v[44:47]
    ds_read_b64_tr_b16 v[96:97], v159 offset:32768
    v_mfma_f32_16x16x32_bf16 v[48:51], v[124:127], v[112:115], v[48:51]
    ds_read_b64_tr_b16 v[98:99], v159 offset:33792
    s_waitcnt lgkmcnt(12)
    v_mfma_f32_16x16x32_bf16 v[52:55], v[128:131], v[100:103], v[52:55]
    v_mfma_f32_16x16x32_bf16 v[56:59], v[128:131], v[104:107], v[56:59]
    v_mfma_f32_16x16x32_bf16 v[60:63], v[128:131], v[108:111], v[60:63]
    v_mfma_f32_16x16x32_bf16 v[64:67], v[128:131], v[112:115], v[64:67]
    s_waitcnt lgkmcnt(6)
    v_mfma_f32_16x16x32_bf16 v[4:7], v[84:87], v[68:71], v[4:7]
    ds_read_b64_tr_b16 v[116:117], v156 offset:40960
    v_mfma_f32_16x16x32_bf16 v[8:11], v[84:87], v[72:75], v[8:11]
    ds_read_b64_tr_b16 v[118:119], v156 offset:41984
    v_mfma_f32_16x16x32_bf16 v[12:15], v[84:87], v[76:79], v[12:15]
    ds_read_b128 v[100:103], v153 offset:32768
    v_mfma_f32_16x16x32_bf16 v[16:19], v[84:87], v[80:83], v[16:19]
    ds_read_b128 v[104:107], v153 offset:34816
    s_waitcnt lgkmcnt(8)
    v_mfma_f32_16x16x32_bf16 v[20:23], v[88:91], v[68:71], v[20:23]
    ds_read_b128 v[108:111], v153 offset:36864
    v_mfma_f32_16x16x32_bf16 v[24:27], v[88:91], v[72:75], v[24:27]
    ds_read_b128 v[112:115], v153 offset:38912
    v_mfma_f32_16x16x32_bf16 v[28:31], v[88:91], v[76:79], v[28:31]
    ds_read_b64_tr_b16 v[120:121], v157 offset:40960
    v_mfma_f32_16x16x32_bf16 v[32:35], v[88:91], v[80:83], v[32:35]
    ds_read_b64_tr_b16 v[122:123], v157 offset:41984
    s_waitcnt lgkmcnt(10)
    v_mfma_f32_16x16x32_bf16 v[36:39], v[92:95], v[68:71], v[36:39]
    ds_read_b64_tr_b16 v[124:125], v158 offset:40960
    v_mfma_f32_16x16x32_bf16 v[40:43], v[92:95], v[72:75], v[40:43]
    ds_read_b64_tr_b16 v[126:127], v158 offset:41984
    v_mfma_f32_16x16x32_bf16 v[44:47], v[92:95], v[76:79], v[44:47]
    ds_read_b64_tr_b16 v[128:129], v159 offset:40960
    v_mfma_f32_16x16x32_bf16 v[48:51], v[92:95], v[80:83], v[48:51]
    ds_read_b64_tr_b16 v[130:131], v159 offset:41984
    s_waitcnt lgkmcnt(12)
    v_mfma_f32_16x16x32_bf16 v[52:55], v[96:99], v[68:71], v[52:55]
    v_mfma_f32_16x16x32_bf16 v[56:59], v[96:99], v[72:75], v[56:59]
    v_mfma_f32_16x16x32_bf16 v[60:63], v[96:99], v[76:79], v[60:63]
    v_mfma_f32_16x16x32_bf16 v[64:67], v[96:99], v[80:83], v[64:67]
    s_waitcnt lgkmcnt(6)
    v_mfma_f32_16x16x32_bf16 v[4:7], v[116:119], v[100:103], v[4:7]
    s_waitcnt lgkmcnt(0)
    s_barrier
    ds_read_b64_tr_b16 v[84:85], v160 offset:0
    v_mfma_f32_16x16x32_bf16 v[8:11], v[116:119], v[104:107], v[8:11]
    ds_read_b64_tr_b16 v[86:87], v160 offset:1024
    v_mfma_f32_16x16x32_bf16 v[12:15], v[116:119], v[108:111], v[12:15]
    ds_read_b128 v[68:71], v154 offset:0
    v_mfma_f32_16x16x32_bf16 v[16:19], v[116:119], v[112:115], v[16:19]
    ds_read_b128 v[72:75], v154 offset:2048
    s_waitcnt lgkmcnt(8)
    v_mfma_f32_16x16x32_bf16 v[20:23], v[120:123], v[100:103], v[20:23]
    ds_read_b128 v[76:79], v154 offset:4096
    v_mfma_f32_16x16x32_bf16 v[24:27], v[120:123], v[104:107], v[24:27]
    ds_read_b128 v[80:83], v154 offset:6144
    v_mfma_f32_16x16x32_bf16 v[28:31], v[120:123], v[108:111], v[28:31]
    ds_read_b64_tr_b16 v[88:89], v161 offset:0
    v_mfma_f32_16x16x32_bf16 v[32:35], v[120:123], v[112:115], v[32:35]
    ds_read_b64_tr_b16 v[90:91], v161 offset:1024
    s_waitcnt lgkmcnt(10)
    v_mfma_f32_16x16x32_bf16 v[36:39], v[124:127], v[100:103], v[36:39]
    ds_read_b64_tr_b16 v[92:93], v162 offset:0
    v_mfma_f32_16x16x32_bf16 v[40:43], v[124:127], v[104:107], v[40:43]
    ds_read_b64_tr_b16 v[94:95], v162 offset:1024
    v_mfma_f32_16x16x32_bf16 v[44:47], v[124:127], v[108:111], v[44:47]
    ds_read_b64_tr_b16 v[96:97], v163 offset:0
    v_mfma_f32_16x16x32_bf16 v[48:51], v[124:127], v[112:115], v[48:51]
    ds_read_b64_tr_b16 v[98:99], v163 offset:1024
    s_waitcnt lgkmcnt(12)
    v_mfma_f32_16x16x32_bf16 v[52:55], v[128:131], v[100:103], v[52:55]
    v_mfma_f32_16x16x32_bf16 v[56:59], v[128:131], v[104:107], v[56:59]
    v_mfma_f32_16x16x32_bf16 v[60:63], v[128:131], v[108:111], v[60:63]
    v_mfma_f32_16x16x32_bf16 v[64:67], v[128:131], v[112:115], v[64:67]
    s_waitcnt lgkmcnt(6)
    v_mfma_f32_16x16x32_bf16 v[4:7], v[84:87], v[68:71], v[4:7]
    ds_read_b64_tr_b16 v[116:117], v160 offset:8192
    v_mfma_f32_16x16x32_bf16 v[8:11], v[84:87], v[72:75], v[8:11]
    ds_read_b64_tr_b16 v[118:119], v160 offset:9216
    v_mfma_f32_16x16x32_bf16 v[12:15], v[84:87], v[76:79], v[12:15]
    ds_read_b128 v[100:103], v155 offset:0
    v_mfma_f32_16x16x32_bf16 v[16:19], v[84:87], v[80:83], v[16:19]
    ds_read_b128 v[104:107], v155 offset:2048
    s_waitcnt lgkmcnt(8)
    v_mfma_f32_16x16x32_bf16 v[20:23], v[88:91], v[68:71], v[20:23]
    ds_read_b128 v[108:111], v155 offset:4096
    v_mfma_f32_16x16x32_bf16 v[24:27], v[88:91], v[72:75], v[24:27]
    ds_read_b128 v[112:115], v155 offset:6144
    v_mfma_f32_16x16x32_bf16 v[28:31], v[88:91], v[76:79], v[28:31]
    ds_read_b64_tr_b16 v[120:121], v161 offset:8192
    v_mfma_f32_16x16x32_bf16 v[32:35], v[88:91], v[80:83], v[32:35]
    ds_read_b64_tr_b16 v[122:123], v161 offset:9216
    s_waitcnt lgkmcnt(10)
    v_mfma_f32_16x16x32_bf16 v[36:39], v[92:95], v[68:71], v[36:39]
    ds_read_b64_tr_b16 v[124:125], v162 offset:8192
    v_mfma_f32_16x16x32_bf16 v[40:43], v[92:95], v[72:75], v[40:43]
    ds_read_b64_tr_b16 v[126:127], v162 offset:9216
    v_mfma_f32_16x16x32_bf16 v[44:47], v[92:95], v[76:79], v[44:47]
    ds_read_b64_tr_b16 v[128:129], v163 offset:8192
    v_mfma_f32_16x16x32_bf16 v[48:51], v[92:95], v[80:83], v[48:51]
    ds_read_b64_tr_b16 v[130:131], v163 offset:9216
    s_waitcnt lgkmcnt(12)
    v_mfma_f32_16x16x32_bf16 v[52:55], v[96:99], v[68:71], v[52:55]
    v_mfma_f32_16x16x32_bf16 v[56:59], v[96:99], v[72:75], v[56:59]
    v_mfma_f32_16x16x32_bf16 v[60:63], v[96:99], v[76:79], v[60:63]
    v_mfma_f32_16x16x32_bf16 v[64:67], v[96:99], v[80:83], v[64:67]
    s_waitcnt lgkmcnt(6)
    v_mfma_f32_16x16x32_bf16 v[4:7], v[116:119], v[100:103], v[4:7]
    s_waitcnt lgkmcnt(0)
    s_barrier
    ds_read_b64_tr_b16 v[84:85], v160 offset:32768
    v_mfma_f32_16x16x32_bf16 v[8:11], v[116:119], v[104:107], v[8:11]
    ds_read_b64_tr_b16 v[86:87], v160 offset:33792
    v_mfma_f32_16x16x32_bf16 v[12:15], v[116:119], v[108:111], v[12:15]
    ds_read_b128 v[68:71], v154 offset:32768
    v_mfma_f32_16x16x32_bf16 v[16:19], v[116:119], v[112:115], v[16:19]
    ds_read_b128 v[72:75], v154 offset:34816
    s_waitcnt lgkmcnt(8)
    v_mfma_f32_16x16x32_bf16 v[20:23], v[120:123], v[100:103], v[20:23]
    ds_read_b128 v[76:79], v154 offset:36864
    v_mfma_f32_16x16x32_bf16 v[24:27], v[120:123], v[104:107], v[24:27]
    ds_read_b128 v[80:83], v154 offset:38912
    v_mfma_f32_16x16x32_bf16 v[28:31], v[120:123], v[108:111], v[28:31]
    ds_read_b64_tr_b16 v[88:89], v161 offset:32768
    v_mfma_f32_16x16x32_bf16 v[32:35], v[120:123], v[112:115], v[32:35]
    ds_read_b64_tr_b16 v[90:91], v161 offset:33792
    s_waitcnt lgkmcnt(10)
    v_mfma_f32_16x16x32_bf16 v[36:39], v[124:127], v[100:103], v[36:39]
    ds_read_b64_tr_b16 v[92:93], v162 offset:32768
    v_mfma_f32_16x16x32_bf16 v[40:43], v[124:127], v[104:107], v[40:43]
    ds_read_b64_tr_b16 v[94:95], v162 offset:33792
    v_mfma_f32_16x16x32_bf16 v[44:47], v[124:127], v[108:111], v[44:47]
    ds_read_b64_tr_b16 v[96:97], v163 offset:32768
    v_mfma_f32_16x16x32_bf16 v[48:51], v[124:127], v[112:115], v[48:51]
    ds_read_b64_tr_b16 v[98:99], v163 offset:33792
    s_waitcnt lgkmcnt(12)
    v_mfma_f32_16x16x32_bf16 v[52:55], v[128:131], v[100:103], v[52:55]
    v_mfma_f32_16x16x32_bf16 v[56:59], v[128:131], v[104:107], v[56:59]
    v_mfma_f32_16x16x32_bf16 v[60:63], v[128:131], v[108:111], v[60:63]
    v_mfma_f32_16x16x32_bf16 v[64:67], v[128:131], v[112:115], v[64:67]
    s_waitcnt lgkmcnt(6)
    v_mfma_f32_16x16x32_bf16 v[4:7], v[84:87], v[68:71], v[4:7]
    ds_read_b64_tr_b16 v[116:117], v160 offset:40960
    v_mfma_f32_16x16x32_bf16 v[8:11], v[84:87], v[72:75], v[8:11]
    ds_read_b64_tr_b16 v[118:119], v160 offset:41984
    v_mfma_f32_16x16x32_bf16 v[12:15], v[84:87], v[76:79], v[12:15]
    ds_read_b128 v[100:103], v155 offset:32768
    v_mfma_f32_16x16x32_bf16 v[16:19], v[84:87], v[80:83], v[16:19]
    ds_read_b128 v[104:107], v155 offset:34816
    s_waitcnt lgkmcnt(8)
    v_mfma_f32_16x16x32_bf16 v[20:23], v[88:91], v[68:71], v[20:23]
    ds_read_b128 v[108:111], v155 offset:36864
    v_mfma_f32_16x16x32_bf16 v[24:27], v[88:91], v[72:75], v[24:27]
    ds_read_b128 v[112:115], v155 offset:38912
    v_mfma_f32_16x16x32_bf16 v[28:31], v[88:91], v[76:79], v[28:31]
    ds_read_b64_tr_b16 v[120:121], v161 offset:40960
    v_mfma_f32_16x16x32_bf16 v[32:35], v[88:91], v[80:83], v[32:35]
    ds_read_b64_tr_b16 v[122:123], v161 offset:41984
    s_waitcnt lgkmcnt(10)
    v_mfma_f32_16x16x32_bf16 v[36:39], v[92:95], v[68:71], v[36:39]
    ds_read_b64_tr_b16 v[124:125], v162 offset:40960
    v_mfma_f32_16x16x32_bf16 v[40:43], v[92:95], v[72:75], v[40:43]
    ds_read_b64_tr_b16 v[126:127], v162 offset:41984
    v_mfma_f32_16x16x32_bf16 v[44:47], v[92:95], v[76:79], v[44:47]
    ds_read_b64_tr_b16 v[128:129], v163 offset:40960
    v_mfma_f32_16x16x32_bf16 v[48:51], v[92:95], v[80:83], v[48:51]
    ds_read_b64_tr_b16 v[130:131], v163 offset:41984
    s_waitcnt lgkmcnt(12)
    v_mfma_f32_16x16x32_bf16 v[52:55], v[96:99], v[68:71], v[52:55]
    v_mfma_f32_16x16x32_bf16 v[56:59], v[96:99], v[72:75], v[56:59]
    v_mfma_f32_16x16x32_bf16 v[60:63], v[96:99], v[76:79], v[60:63]
    v_mfma_f32_16x16x32_bf16 v[64:67], v[96:99], v[80:83], v[64:67]
    s_waitcnt lgkmcnt(6)
    v_mfma_f32_16x16x32_bf16 v[4:7], v[116:119], v[100:103], v[4:7]
    s_waitcnt lgkmcnt(0)
    s_barrier
    ds_read_b64_tr_b16 v[84:85], v156 offset:0
    v_mfma_f32_16x16x32_bf16 v[8:11], v[116:119], v[104:107], v[8:11]
    ds_read_b64_tr_b16 v[86:87], v156 offset:1024
    v_mfma_f32_16x16x32_bf16 v[12:15], v[116:119], v[108:111], v[12:15]
    ds_read_b128 v[68:71], v152 offset:0
    v_mfma_f32_16x16x32_bf16 v[16:19], v[116:119], v[112:115], v[16:19]
    ds_read_b128 v[72:75], v152 offset:2048
    s_waitcnt lgkmcnt(8)
    v_mfma_f32_16x16x32_bf16 v[20:23], v[120:123], v[100:103], v[20:23]
    ds_read_b128 v[76:79], v152 offset:4096
    v_mfma_f32_16x16x32_bf16 v[24:27], v[120:123], v[104:107], v[24:27]
    ds_read_b128 v[80:83], v152 offset:6144
    v_mfma_f32_16x16x32_bf16 v[28:31], v[120:123], v[108:111], v[28:31]
    ds_read_b64_tr_b16 v[88:89], v157 offset:0
    v_mfma_f32_16x16x32_bf16 v[32:35], v[120:123], v[112:115], v[32:35]
    ds_read_b64_tr_b16 v[90:91], v157 offset:1024
    s_waitcnt lgkmcnt(10)
    v_mfma_f32_16x16x32_bf16 v[36:39], v[124:127], v[100:103], v[36:39]
    ds_read_b64_tr_b16 v[92:93], v158 offset:0
    v_mfma_f32_16x16x32_bf16 v[40:43], v[124:127], v[104:107], v[40:43]
    ds_read_b64_tr_b16 v[94:95], v158 offset:1024
    v_mfma_f32_16x16x32_bf16 v[44:47], v[124:127], v[108:111], v[44:47]
    ds_read_b64_tr_b16 v[96:97], v159 offset:0
    v_mfma_f32_16x16x32_bf16 v[48:51], v[124:127], v[112:115], v[48:51]
    ds_read_b64_tr_b16 v[98:99], v159 offset:1024
    s_waitcnt lgkmcnt(12)
    v_mfma_f32_16x16x32_bf16 v[52:55], v[128:131], v[100:103], v[52:55]
    v_mfma_f32_16x16x32_bf16 v[56:59], v[128:131], v[104:107], v[56:59]
    v_mfma_f32_16x16x32_bf16 v[60:63], v[128:131], v[108:111], v[60:63]
    v_mfma_f32_16x16x32_bf16 v[64:67], v[128:131], v[112:115], v[64:67]
    s_waitcnt lgkmcnt(6)
    v_mfma_f32_16x16x32_bf16 v[4:7], v[84:87], v[68:71], v[4:7]
    ds_read_b64_tr_b16 v[116:117], v156 offset:8192
    v_mfma_f32_16x16x32_bf16 v[8:11], v[84:87], v[72:75], v[8:11]
    ds_read_b64_tr_b16 v[118:119], v156 offset:9216
    v_mfma_f32_16x16x32_bf16 v[12:15], v[84:87], v[76:79], v[12:15]
    ds_read_b128 v[100:103], v153 offset:0
    v_mfma_f32_16x16x32_bf16 v[16:19], v[84:87], v[80:83], v[16:19]
    ds_read_b128 v[104:107], v153 offset:2048
    s_waitcnt lgkmcnt(8)
    v_mfma_f32_16x16x32_bf16 v[20:23], v[88:91], v[68:71], v[20:23]
    ds_read_b128 v[108:111], v153 offset:4096
    v_mfma_f32_16x16x32_bf16 v[24:27], v[88:91], v[72:75], v[24:27]
    ds_read_b128 v[112:115], v153 offset:6144
    v_mfma_f32_16x16x32_bf16 v[28:31], v[88:91], v[76:79], v[28:31]
    ds_read_b64_tr_b16 v[120:121], v157 offset:8192
    v_mfma_f32_16x16x32_bf16 v[32:35], v[88:91], v[80:83], v[32:35]
    ds_read_b64_tr_b16 v[122:123], v157 offset:9216
    s_waitcnt lgkmcnt(10)
    v_mfma_f32_16x16x32_bf16 v[36:39], v[92:95], v[68:71], v[36:39]
    ds_read_b64_tr_b16 v[124:125], v158 offset:8192
    v_mfma_f32_16x16x32_bf16 v[40:43], v[92:95], v[72:75], v[40:43]
    ds_read_b64_tr_b16 v[126:127], v158 offset:9216
    v_mfma_f32_16x16x32_bf16 v[44:47], v[92:95], v[76:79], v[44:47]
    ds_read_b64_tr_b16 v[128:129], v159 offset:8192
    v_mfma_f32_16x16x32_bf16 v[48:51], v[92:95], v[80:83], v[48:51]
    ds_read_b64_tr_b16 v[130:131], v159 offset:9216
    s_waitcnt lgkmcnt(12)
    v_mfma_f32_16x16x32_bf16 v[52:55], v[96:99], v[68:71], v[52:55]
    ds_read_b32 v165, v1 offset:128
    v_mfma_f32_16x16x32_bf16 v[56:59], v[96:99], v[72:75], v[56:59]
    ds_read_b32 v166, v1 offset:32
    v_mfma_f32_16x16x32_bf16 v[60:63], v[96:99], v[76:79], v[60:63]
    v_mfma_f32_16x16x32_bf16 v[64:67], v[96:99], v[80:83], v[64:67]
    s_waitcnt lgkmcnt(8)
    v_mfma_f32_16x16x32_bf16 v[4:7], v[116:119], v[100:103], v[4:7]
    v_mfma_f32_16x16x32_bf16 v[8:11], v[116:119], v[104:107], v[8:11]
    v_mfma_f32_16x16x32_bf16 v[12:15], v[116:119], v[108:111], v[12:15]
    v_mfma_f32_16x16x32_bf16 v[16:19], v[116:119], v[112:115], v[16:19]
    s_waitcnt lgkmcnt(6)
    v_mfma_f32_16x16x32_bf16 v[20:23], v[120:123], v[100:103], v[20:23]
    v_mfma_f32_16x16x32_bf16 v[24:27], v[120:123], v[104:107], v[24:27]
    v_mfma_f32_16x16x32_bf16 v[28:31], v[120:123], v[108:111], v[28:31]
    v_mfma_f32_16x16x32_bf16 v[32:35], v[120:123], v[112:115], v[32:35]
    s_waitcnt lgkmcnt(4)
    v_mfma_f32_16x16x32_bf16 v[36:39], v[124:127], v[100:103], v[36:39]
    v_mfma_f32_16x16x32_bf16 v[40:43], v[124:127], v[104:107], v[40:43]
    v_mfma_f32_16x16x32_bf16 v[44:47], v[124:127], v[108:111], v[44:47]
    v_mfma_f32_16x16x32_bf16 v[48:51], v[124:127], v[112:115], v[48:51]
    s_waitcnt lgkmcnt(2)
    v_mfma_f32_16x16x32_bf16 v[52:55], v[128:131], v[100:103], v[52:55]
    v_mfma_f32_16x16x32_bf16 v[56:59], v[128:131], v[104:107], v[56:59]
    v_mfma_f32_16x16x32_bf16 v[60:63], v[128:131], v[108:111], v[60:63]
    v_mfma_f32_16x16x32_bf16 v[64:67], v[128:131], v[112:115], v[64:67]
    s_waitcnt lgkmcnt(0)
    v_readfirstlane_b32 s31, v165
    v_readfirstlane_b32 s40, v166
    s_cmp_lt_u32 s33, 5
    s_cbranch_scc1 RC_Q
    s_mov_b32 s40, 2
    s_barrier
    ds_read_b64_tr_b16 v[84:85], v156 offset:32768
    ds_read_b64_tr_b16 v[86:87], v156 offset:33792
    ds_read_b128 v[68:71], v152 offset:32768
    ds_read_b128 v[72:75], v152 offset:34816
    ds_read_b128 v[76:79], v152 offset:36864
    ds_read_b128 v[80:83], v152 offset:38912
    ds_read_b64_tr_b16 v[116:117], v156 offset:40960
    ds_read_b64_tr_b16 v[118:119], v156 offset:41984
    ds_read_b128 v[100:103], v153 offset:32768
    ds_read_b128 v[104:107], v153 offset:34816
    ds_read_b128 v[108:111], v153 offset:36864
    ds_read_b128 v[112:115], v153 offset:38912
    ds_read_b64_tr_b16 v[88:89], v157 offset:32768
    ds_read_b64_tr_b16 v[90:91], v157 offset:33792
    s_waitcnt lgkmcnt(8)
    v_mfma_f32_16x16x32_bf16 v[4:7], v[84:87], v[68:71], v[4:7]
    ds_read_b64_tr_b16 v[120:121], v157 offset:40960
    v_mfma_f32_16x16x32_bf16 v[8:11], v[84:87], v[72:75], v[8:11]
    ds_read_b64_tr_b16 v[122:123], v157 offset:41984
    v_mfma_f32_16x16x32_bf16 v[12:15], v[84:87], v[76:79], v[12:15]
    ds_read_b64_tr_b16 v[92:93], v158 offset:32768
    v_mfma_f32_16x16x32_bf16 v[16:19], v[84:87], v[80:83], v[16:19]
    ds_read_b64_tr_b16 v[94:95], v158 offset:33792
    s_waitcnt lgkmcnt(6)
    v_mfma_f32_16x16x32_bf16 v[4:7], v[116:119], v[100:103], v[4:7]
    ds_read_b64_tr_b16 v[124:125], v158 offset:40960
    v_mfma_f32_16x16x32_bf16 v[8:11], v[116:119], v[104:107], v[8:11]
    ds_read_b64_tr_b16 v[126:127], v158 offset:41984
    v_mfma_f32_16x16x32_bf16 v[12:15], v[116:119], v[108:111], v[12:15]
    ds_read_b64_tr_b16 v[96:97], v159 offset:32768
    v_mfma_f32_16x16x32_bf16 v[16:19], v[116:119], v[112:115], v[16:19]
    ds_read_b64_tr_b16 v[98:99], v159 offset:33792
    s_waitcnt lgkmcnt(8)
    v_mfma_f32_16x16x32_bf16 v[20:23], v[88:91], v[68:71], v[20:23]
    ds_read_b64_tr_b16 v[128:129], v159 offset:40960
    v_mfma_f32_16x16x32_bf16 v[24:27], v[88:91], v[72:75], v[24:27]
    ds_read_b64_tr_b16 v[130:131], v159 offset:41984
    v_mfma_f32_16x16x32_bf16 v[28:31], v[88:91], v[76:79], v[28:31]
    s_mov_b64 exec, 1
    ds_add_u32 v1, v2 offset:72
    s_mov_b64 exec, -1
    v_mfma_f32_16x16x32_bf16 v[32:35], v[88:91], v[80:83], v[32:35]
    s_add_u32 s39, s38, 0
    v_cvt_pk_bf16_f32 v4, v4, v5
    v_cvt_pk_bf16_f32 v5, v6, v7
    v_cvt_pk_bf16_f32 v6, v8, v9
    v_cvt_pk_bf16_f32 v7, v10, v11
    buffer_store_dwordx4 v[4:7], v164, s[48:51], s39 offen offset:0 sc1
    v_cvt_pk_bf16_f32 v12, v12, v13
    v_cvt_pk_bf16_f32 v13, v14, v15
    v_cvt_pk_bf16_f32 v14, v16, v17
    v_cvt_pk_bf16_f32 v15, v18, v19
    buffer_store_dwordx4 v[12:15], v164, s[48:51], s39 offen offset:256 sc1
    s_waitcnt lgkmcnt(9)
    v_mfma_f32_16x16x32_bf16 v[20:23], v[120:123], v[100:103], v[20:23]
    v_mfma_f32_16x16x32_bf16 v[24:27], v[120:123], v[104:107], v[24:27]
    v_mfma_f32_16x16x32_bf16 v[28:31], v[120:123], v[108:111], v[28:31]
    v_mfma_f32_16x16x32_bf16 v[32:35], v[120:123], v[112:115], v[32:35]
    s_waitcnt lgkmcnt(7)
    v_mfma_f32_16x16x32_bf16 v[36:39], v[92:95], v[68:71], v[36:39]
    v_mfma_f32_16x16x32_bf16 v[40:43], v[92:95], v[72:75], v[40:43]
    v_mfma_f32_16x16x32_bf16 v[44:47], v[92:95], v[76:79], v[44:47]
    v_mfma_f32_16x16x32_bf16 v[48:51], v[92:95], v[80:83], v[48:51]
    s_add_u32 s39, s38, 66560
    v_cvt_pk_bf16_f32 v20, v20, v21
    v_cvt_pk_bf16_f32 v21, v22, v23
    v_cvt_pk_bf16_f32 v22, v24, v25
    v_cvt_pk_bf16_f32 v23, v26, v27
    buffer_store_dwordx4 v[20:23], v164, s[48:51], s39 offen offset:0 sc1
    v_cvt_pk_bf16_f32 v28, v28, v29
    v_cvt_pk_bf16_f32 v29, v30, v31
    v_cvt_pk_bf16_f32 v30, v32, v33
    v_cvt_pk_bf16_f32 v31, v34, v35
    buffer_store_dwordx4 v[28:31], v164, s[48:51], s39 offen offset:256 sc1
    s_waitcnt lgkmcnt(5)
    v_mfma_f32_16x16x32_bf16 v[36:39], v[124:127], v[100:103], v[36:39]
    v_mfma_f32_16x16x32_bf16 v[40:43], v[124:127], v[104:107], v[40:43]
    v_mfma_f32_16x16x32_bf16 v[44:47], v[124:127], v[108:111], v[44:47]
    v_mfma_f32_16x16x32_bf16 v[48:51], v[124:127], v[112:115], v[48:51]
    s_waitcnt lgkmcnt(3)
    v_mfma_f32_16x16x32_bf16 v[52:55], v[96:99], v[68:71], v[52:55]
    v_mfma_f32_16x16x32_bf16 v[56:59], v[96:99], v[72:75], v[56:59]
    v_mfma_f32_16x16x32_bf16 v[60:63], v[96:99], v[76:79], v[60:63]
    v_mfma_f32_16x16x32_bf16 v[64:67], v[96:99], v[80:83], v[64:67]
    s_add_u32 s39, s38, 133120
    v_cvt_pk_bf16_f32 v36, v36, v37
    v_cvt_pk_bf16_f32 v37, v38, v39
    v_cvt_pk_bf16_f32 v38, v40, v41
    v_cvt_pk_bf16_f32 v39, v42, v43
    buffer_store_dwordx4 v[36:39], v164, s[48:51], s39 offen offset:0 sc1
    v_cvt_pk_bf16_f32 v44, v44, v45
    v_cvt_pk_bf16_f32 v45, v46, v47
    v_cvt_pk_bf16_f32 v46, v48, v49
    v_cvt_pk_bf16_f32 v47, v50, v51
    buffer_store_dwordx4 v[44:47], v164, s[48:51], s39 offen offset:256 sc1
    s_waitcnt lgkmcnt(1)
    v_mfma_f32_16x16x32_bf16 v[52:55], v[128:131], v[100:103], v[52:55]
    v_mfma_f32_16x16x32_bf16 v[56:59], v[128:131], v[104:107], v[56:59]
    v_mfma_f32_16x16x32_bf16 v[60:63], v[128:131], v[108:111], v[60:63]
    v_mfma_f32_16x16x32_bf16 v[64:67], v[128:131], v[112:115], v[64:67]
    s_add_u32 s39, s38, 199680
    s_nop 3
    v_cvt_pk_bf16_f32 v52, v52, v53
    v_cvt_pk_bf16_f32 v53, v54, v55
    v_cvt_pk_bf16_f32 v54, v56, v57
    v_cvt_pk_bf16_f32 v55, v58, v59
    buffer_store_dwordx4 v[52:55], v164, s[48:51], s39 offen offset:0 sc1
    v_cvt_pk_bf16_f32 v60, v60, v61
    v_cvt_pk_bf16_f32 v61, v62, v63
    v_cvt_pk_bf16_f32 v62, v64, v65
    v_cvt_pk_bf16_f32 v63, v66, v67
    buffer_store_dwordx4 v[60:63], v164, s[48:51], s39 offen offset:256 sc1
    s_branch RC_STD
RC_Q:
    s_cmp_lg_u32 s40, 0
    s_cbranch_scc1 RC_HAVEM
    s_barrier
    s_mov_b32 s46, 16777216
LW_41:
    ds_read_b32 v165, v1 offset:32
    s_sub_u32 s46, s46, 1
    s_cbranch_scc1 LW_42
    s_waitcnt lgkmcnt(0)
    v_readfirstlane_b32 s40, v165
    s_nop 0
    s_cmp_ge_u32 s40, 1
    s_cbranch_scc1 LW_42
    s_sleep 1
    s_branch LW_41
LW_42:
    s_cmp_eq_u32 s40, 1
    s_cbranch_scc1 RC_PBP
    s_branch RC_PBS
RC_HAVEM:
    s_cmp_eq_u32 s40, 1
    s_cbranch_scc1 RC_PL
    s_barrier
RC_PBS:
    ds_read_b64_tr_b16 v[84:85], v156 offset:32768
    ds_read_b64_tr_b16 v[86:87], v156 offset:33792
    ds_read_b128 v[68:71], v152 offset:32768
    ds_read_b128 v[72:75], v152 offset:34816
    ds_read_b128 v[76:79], v152 offset:36864
    ds_read_b128 v[80:83], v152 offset:38912
    ds_read_b64_tr_b16 v[116:117], v156 offset:40960
    ds_read_b64_tr_b16 v[118:119], v156 offset:41984
    ds_read_b128 v[100:103], v153 offset:32768
    ds_read_b128 v[104:107], v153 offset:34816
    ds_read_b128 v[108:111], v153 offset:36864
    ds_read_b128 v[112:115], v153 offset:38912
    ds_read_b64_tr_b16 v[88:89], v157 offset:32768
    ds_read_b64_tr_b16 v[90:91], v157 offset:33792
    s_waitcnt lgkmcnt(8)
    v_mfma_f32_16x16x32_bf16 v[4:7], v[84:87], v[68:71], v[4:7]
    ds_read_b64_tr_b16 v[120:121], v157 offset:40960
    v_mfma_f32_16x16x32_bf16 v[8:11], v[84:87], v[72:75], v[8:11]
    ds_read_b64_tr_b16 v[122:123], v157 offset:41984
    v_mfma_f32_16x16x32_bf16 v[12:15], v[84:87], v[76:79], v[12:15]
    ds_read_b64_tr_b16 v[92:93], v158 offset:32768
    v_mfma_f32_16x16x32_bf16 v[16:19], v[84:87], v[80:83], v[16:19]
    ds_read_b64_tr_b16 v[94:95], v158 offset:33792
    s_waitcnt lgkmcnt(6)
    v_mfma_f32_16x16x32_bf16 v[4:7], v[116:119], v[100:103], v[4:7]
    ds_read_b64_tr_b16 v[124:125], v158 offset:40960
    v_mfma_f32_16x16x32_bf16 v[8:11], v[116:119], v[104:107], v[8:11]
    ds_read_b64_tr_b16 v[126:127], v158 offset:41984
    v_mfma_f32_16x16x32_bf16 v[12:15], v[116:119], v[108:111], v[12:15]
    ds_read_b64_tr_b16 v[96:97], v159 offset:32768
    v_mfma_f32_16x16x32_bf16 v[16:19], v[116:119], v[112:115], v[16:19]
    ds_read_b64_tr_b16 v[98:99], v159 offset:33792
    s_waitcnt lgkmcnt(8)
    v_mfma_f32_16x16x32_bf16 v[20:23], v[88:91], v[68:71], v[20:23]
    ds_read_b64_tr_b16 v[128:129], v159 offset:40960
    v_mfma_f32_16x16x32_bf16 v[24:27], v[88:91], v[72:75], v[24:27]
    ds_read_b64_tr_b16 v[130:131], v159 offset:41984
    v_mfma_f32_16x16x32_bf16 v[28:31], v[88:91], v[76:79], v[28:31]
    s_mov_b64 exec, 1
    ds_add_u32 v1, v2 offset:72
    s_mov_b64 exec, -1
    v_mfma_f32_16x16x32_bf16 v[32:35], v[88:91], v[80:83], v[32:35]
    s_add_u32 s39, s38, 0
    v_pk_mul_f32 v[4:5], v[4:5], s[42:43]
    v_pk_mul_f32 v[6:7], v[6:7], s[42:43]
    v_cvt_pk_bf16_f32 v4, v4, v5
    v_cvt_pk_bf16_f32 v5, v6, v7
    v_pk_mul_f32 v[8:9], v[8:9], s[42:43]
    v_pk_mul_f32 v[10:11], v[10:11], s[42:43]
    v_cvt_pk_bf16_f32 v6, v8, v9
    v_cvt_pk_bf16_f32 v7, v10, v11
    buffer_store_dwordx4 v[4:7], v164, s[48:51], s39 offen offset:0 sc1
    v_pk_mul_f32 v[12:13], v[12:13], s[42:43]
    v_pk_mul_f32 v[14:15], v[14:15], s[42:43]
    v_cvt_pk_bf16_f32 v12, v12, v13
    v_cvt_pk_bf16_f32 v13, v14, v15
    v_pk_mul_f32 v[16:17], v[16:17], s[42:43]
    v_pk_mul_f32 v[18:19], v[18:19], s[42:43]
    v_cvt_pk_bf16_f32 v14, v16, v17
    v_cvt_pk_bf16_f32 v15, v18, v19
    buffer_store_dwordx4 v[12:15], v164, s[48:51], s39 offen offset:256 sc1
    s_waitcnt lgkmcnt(9)
    v_mfma_f32_16x16x32_bf16 v[20:23], v[120:123], v[100:103], v[20:23]
    v_mfma_f32_16x16x32_bf16 v[24:27], v[120:123], v[104:107], v[24:27]
    v_mfma_f32_16x16x32_bf16 v[28:31], v[120:123], v[108:111], v[28:31]
    v_mfma_f32_16x16x32_bf16 v[32:35], v[120:123], v[112:115], v[32:35]
    s_waitcnt lgkmcnt(7)
    v_mfma_f32_16x16x32_bf16 v[36:39], v[92:95], v[68:71], v[36:39]
    v_mfma_f32_16x16x32_bf16 v[40:43], v[92:95], v[72:75], v[40:43]
    v_mfma_f32_16x16x32_bf16 v[44:47], v[92:95], v[76:79], v[44:47]
    v_mfma_f32_16x16x32_bf16 v[48:51], v[92:95], v[80:83], v[48:51]
    s_add_u32 s39, s38, 66560
    v_pk_mul_f32 v[20:21], v[20:21], s[42:43]
    v_pk_mul_f32 v[22:23], v[22:23], s[42:43]
    v_cvt_pk_bf16_f32 v20, v20, v21
    v_cvt_pk_bf16_f32 v21, v22, v23
    v_pk_mul_f32 v[24:25], v[24:25], s[42:43]
    v_pk_mul_f32 v[26:27], v[26:27], s[42:43]
    v_cvt_pk_bf16_f32 v22, v24, v25
    v_cvt_pk_bf16_f32 v23, v26, v27
    buffer_store_dwordx4 v[20:23], v164, s[48:51], s39 offen offset:0 sc1
    v_pk_mul_f32 v[28:29], v[28:29], s[42:43]
    v_pk_mul_f32 v[30:31], v[30:31], s[42:43]
    v_cvt_pk_bf16_f32 v28, v28, v29
    v_cvt_pk_bf16_f32 v29, v30, v31
    v_pk_mul_f32 v[32:33], v[32:33], s[42:43]
    v_pk_mul_f32 v[34:35], v[34:35], s[42:43]
    v_cvt_pk_bf16_f32 v30, v32, v33
    v_cvt_pk_bf16_f32 v31, v34, v35
    buffer_store_dwordx4 v[28:31], v164, s[48:51], s39 offen offset:256 sc1
    s_waitcnt lgkmcnt(5)
    v_mfma_f32_16x16x32_bf16 v[36:39], v[124:127], v[100:103], v[36:39]
    v_mfma_f32_16x16x32_bf16 v[40:43], v[124:127], v[104:107], v[40:43]
    v_mfma_f32_16x16x32_bf16 v[44:47], v[124:127], v[108:111], v[44:47]
    v_mfma_f32_16x16x32_bf16 v[48:51], v[124:127], v[112:115], v[48:51]
    s_waitcnt lgkmcnt(3)
    v_mfma_f32_16x16x32_bf16 v[52:55], v[96:99], v[68:71], v[52:55]
    v_mfma_f32_16x16x32_bf16 v[56:59], v[96:99], v[72:75], v[56:59]
    v_mfma_f32_16x16x32_bf16 v[60:63], v[96:99], v[76:79], v[60:63]
    v_mfma_f32_16x16x32_bf16 v[64:67], v[96:99], v[80:83], v[64:67]
    s_add_u32 s39, s38, 133120
    v_pk_mul_f32 v[36:37], v[36:37], s[42:43]
    v_pk_mul_f32 v[38:39], v[38:39], s[42:43]
    v_cvt_pk_bf16_f32 v36, v36, v37
    v_cvt_pk_bf16_f32 v37, v38, v39
    v_pk_mul_f32 v[40:41], v[40:41], s[42:43]
    v_pk_mul_f32 v[42:43], v[42:43], s[42:43]
    v_cvt_pk_bf16_f32 v38, v40, v41
    v_cvt_pk_bf16_f32 v39, v42, v43
    buffer_store_dwordx4 v[36:39], v164, s[48:51], s39 offen offset:0 sc1
    v_pk_mul_f32 v[44:45], v[44:45], s[42:43]
    v_pk_mul_f32 v[46:47], v[46:47], s[42:43]
    v_cvt_pk_bf16_f32 v44, v44, v45
    v_cvt_pk_bf16_f32 v45, v46, v47
    v_pk_mul_f32 v[48:49], v[48:49], s[42:43]
    v_pk_mul_f32 v[50:51], v[50:51], s[42:43]
    v_cvt_pk_bf16_f32 v46, v48, v49
    v_cvt_pk_bf16_f32 v47, v50, v51
    buffer_store_dwordx4 v[44:47], v164, s[48:51], s39 offen offset:256 sc1
    s_waitcnt lgkmcnt(1)
    v_mfma_f32_16x16x32_bf16 v[52:55], v[128:131], v[100:103], v[52:55]
    v_mfma_f32_16x16x32_bf16 v[56:59], v[128:131], v[104:107], v[56:59]
    v_mfma_f32_16x16x32_bf16 v[60:63], v[128:131], v[108:111], v[60:63]
    v_mfma_f32_16x16x32_bf16 v[64:67], v[128:131], v[112:115], v[64:67]
    s_add_u32 s39, s38, 199680
    s_nop 3
    v_pk_mul_f32 v[52:53], v[52:53], s[42:43]
    v_pk_mul_f32 v[54:55], v[54:55], s[42:43]
    v_cvt_pk_bf16_f32 v52, v52, v53
    v_cvt_pk_bf16_f32 v53, v54, v55
    v_pk_mul_f32 v[56:57], v[56:57], s[42:43]
    v_pk_mul_f32 v[58:59], v[58:59], s[42:43]
    v_cvt_pk_bf16_f32 v54, v56, v57
    v_cvt_pk_bf16_f32 v55, v58, v59
    buffer_store_dwordx4 v[52:55], v164, s[48:51], s39 offen offset:0 sc1
    v_pk_mul_f32 v[60:61], v[60:61], s[42:43]
    v_pk_mul_f32 v[62:63], v[62:63], s[42:43]
    v_cvt_pk_bf16_f32 v60, v60, v61
    v_cvt_pk_bf16_f32 v61, v62, v63
    v_pk_mul_f32 v[64:65], v[64:65], s[42:43]
    v_pk_mul_f32 v[66:67], v[66:67], s[42:43]
    v_cvt_pk_bf16_f32 v62, v64, v65
    v_cvt_pk_bf16_f32 v63, v66, v67
    buffer_store_dwordx4 v[60:63], v164, s[48:51], s39 offen offset:256 sc1
    s_branch RC_STD
RC_PL:
    s_barrier
RC_PBP:
    ds_read_b64_tr_b16 v[84:85], v156 offset:32768
    ds_read_b64_tr_b16 v[86:87], v156 offset:33792
    ds_read_b128 v[68:71], v152 offset:32768
    ds_read_b128 v[72:75], v152 offset:34816
    ds_read_b128 v[76:79], v152 offset:36864
    ds_read_b128 v[80:83], v152 offset:38912
    ds_read_b64_tr_b16 v[116:117], v156 offset:40960
    ds_read_b64_tr_b16 v[118:119], v156 offset:41984
    ds_read_b128 v[100:103], v153 offset:32768
    ds_read_b128 v[104:107], v153 offset:34816
    ds_read_b128 v[108:111], v153 offset:36864
    ds_read_b128 v[112:115], v153 offset:38912
    ds_read_b64_tr_b16 v[88:89], v157 offset:32768
    ds_read_b64_tr_b16 v[90:91], v157 offset:33792
    s_waitcnt lgkmcnt(8)
    v_mfma_f32_16x16x32_bf16 v[4:7], v[84:87], v[68:71], v[4:7]
    ds_read_b64_tr_b16 v[120:121], v157 offset:40960
    v_mfma_f32_16x16x32_bf16 v[8:11], v[84:87], v[72:75], v[8:11]
    ds_read_b64_tr_b16 v[122:123], v157 offset:41984
    v_mfma_f32_16x16x32_bf16 v[12:15], v[84:87], v[76:79], v[12:15]
    ds_read_b64_tr_b16 v[92:93], v158 offset:32768
    v_mfma_f32_16x16x32_bf16 v[16:19], v[84:87], v[80:83], v[16:19]
    ds_read_b64_tr_b16 v[94:95], v158 offset:33792
    s_waitcnt lgkmcnt(6)
    v_mfma_f32_16x16x32_bf16 v[4:7], v[116:119], v[100:103], v[4:7]
    ds_read_b64_tr_b16 v[124:125], v158 offset:40960
    v_mfma_f32_16x16x32_bf16 v[8:11], v[116:119], v[104:107], v[8:11]
    ds_read_b64_tr_b16 v[126:127], v158 offset:41984
    v_mfma_f32_16x16x32_bf16 v[12:15], v[116:119], v[108:111], v[12:15]
    ds_read_b64_tr_b16 v[96:97], v159 offset:32768
    v_mfma_f32_16x16x32_bf16 v[16:19], v[116:119], v[112:115], v[16:19]
    ds_read_b64_tr_b16 v[98:99], v159 offset:33792
    s_waitcnt lgkmcnt(8)
    v_mfma_f32_16x16x32_bf16 v[20:23], v[88:91], v[68:71], v[20:23]
    ds_read_b64_tr_b16 v[128:129], v159 offset:40960
    v_mfma_f32_16x16x32_bf16 v[24:27], v[88:91], v[72:75], v[24:27]
    ds_read_b64_tr_b16 v[130:131], v159 offset:41984
    v_mfma_f32_16x16x32_bf16 v[28:31], v[88:91], v[76:79], v[28:31]
    s_mov_b64 exec, 1
    ds_add_u32 v1, v2 offset:72
    s_mov_b64 exec, -1
    v_mfma_f32_16x16x32_bf16 v[32:35], v[88:91], v[80:83], v[32:35]
    s_add_u32 s39, s38, 0
    v_pk_mul_f32 v[4:5], v[4:5], s[42:43]
    v_pk_mul_f32 v[6:7], v[6:7], s[42:43]
    v_cvt_pk_bf16_f32 v4, v4, v5
    v_cvt_pk_bf16_f32 v5, v6, v7
    v_pk_mul_f32 v[8:9], v[8:9], s[42:43]
    v_pk_mul_f32 v[10:11], v[10:11], s[42:43]
    v_cvt_pk_bf16_f32 v6, v8, v9
    v_cvt_pk_bf16_f32 v7, v10, v11
    buffer_store_dwordx4 v[4:7], v164, s[48:51], s39 offen offset:0
    v_pk_mul_f32 v[12:13], v[12:13], s[42:43]
    v_pk_mul_f32 v[14:15], v[14:15], s[42:43]
    v_cvt_pk_bf16_f32 v12, v12, v13
    v_cvt_pk_bf16_f32 v13, v14, v15
    v_pk_mul_f32 v[16:17], v[16:17], s[42:43]
    v_pk_mul_f32 v[18:19], v[18:19], s[42:43]
    v_cvt_pk_bf16_f32 v14, v16, v17
    v_cvt_pk_bf16_f32 v15, v18, v19
    buffer_store_dwordx4 v[12:15], v164, s[48:51], s39 offen offset:256
    s_waitcnt lgkmcnt(9)
    v_mfma_f32_16x16x32_bf16 v[20:23], v[120:123], v[100:103], v[20:23]
    v_mfma_f32_16x16x32_bf16 v[24:27], v[120:123], v[104:107], v[24:27]
    v_mfma_f32_16x16x32_bf16 v[28:31], v[120:123], v[108:111], v[28:31]
    v_mfma_f32_16x16x32_bf16 v[32:35], v[120:123], v[112:115], v[32:35]
    s_waitcnt lgkmcnt(7)
    v_mfma_f32_16x16x32_bf16 v[36:39], v[92:95], v[68:71], v[36:39]
    v_mfma_f32_16x16x32_bf16 v[40:43], v[92:95], v[72:75], v[40:43]
    v_mfma_f32_16x16x32_bf16 v[44:47], v[92:95], v[76:79], v[44:47]
    v_mfma_f32_16x16x32_bf16 v[48:51], v[92:95], v[80:83], v[48:51]
    s_add_u32 s39, s38, 66560
    v_pk_mul_f32 v[20:21], v[20:21], s[42:43]
    v_pk_mul_f32 v[22:23], v[22:23], s[42:43]
    v_cvt_pk_bf16_f32 v20, v20, v21
    v_cvt_pk_bf16_f32 v21, v22, v23
    v_pk_mul_f32 v[24:25], v[24:25], s[42:43]
    v_pk_mul_f32 v[26:27], v[26:27], s[42:43]
    v_cvt_pk_bf16_f32 v22, v24, v25
    v_cvt_pk_bf16_f32 v23, v26, v27
    buffer_store_dwordx4 v[20:23], v164, s[48:51], s39 offen offset:0
    v_pk_mul_f32 v[28:29], v[28:29], s[42:43]
    v_pk_mul_f32 v[30:31], v[30:31], s[42:43]
    v_cvt_pk_bf16_f32 v28, v28, v29
    v_cvt_pk_bf16_f32 v29, v30, v31
    v_pk_mul_f32 v[32:33], v[32:33], s[42:43]
    v_pk_mul_f32 v[34:35], v[34:35], s[42:43]
    v_cvt_pk_bf16_f32 v30, v32, v33
    v_cvt_pk_bf16_f32 v31, v34, v35
    buffer_store_dwordx4 v[28:31], v164, s[48:51], s39 offen offset:256
    s_waitcnt lgkmcnt(5)
    v_mfma_f32_16x16x32_bf16 v[36:39], v[124:127], v[100:103], v[36:39]
    v_mfma_f32_16x16x32_bf16 v[40:43], v[124:127], v[104:107], v[40:43]
    v_mfma_f32_16x16x32_bf16 v[44:47], v[124:127], v[108:111], v[44:47]
    v_mfma_f32_16x16x32_bf16 v[48:51], v[124:127], v[112:115], v[48:51]
    s_waitcnt lgkmcnt(3)
    v_mfma_f32_16x16x32_bf16 v[52:55], v[96:99], v[68:71], v[52:55]
    v_mfma_f32_16x16x32_bf16 v[56:59], v[96:99], v[72:75], v[56:59]
    v_mfma_f32_16x16x32_bf16 v[60:63], v[96:99], v[76:79], v[60:63]
    v_mfma_f32_16x16x32_bf16 v[64:67], v[96:99], v[80:83], v[64:67]
    s_add_u32 s39, s38, 133120
    v_pk_mul_f32 v[36:37], v[36:37], s[42:43]
    v_pk_mul_f32 v[38:39], v[38:39], s[42:43]
    v_cvt_pk_bf16_f32 v36, v36, v37
    v_cvt_pk_bf16_f32 v37, v38, v39
    v_pk_mul_f32 v[40:41], v[40:41], s[42:43]
    v_pk_mul_f32 v[42:43], v[42:43], s[42:43]
    v_cvt_pk_bf16_f32 v38, v40, v41
    v_cvt_pk_bf16_f32 v39, v42, v43
    buffer_store_dwordx4 v[36:39], v164, s[48:51], s39 offen offset:0
    v_pk_mul_f32 v[44:45], v[44:45], s[42:43]
    v_pk_mul_f32 v[46:47], v[46:47], s[42:43]
    v_cvt_pk_bf16_f32 v44, v44, v45
    v_cvt_pk_bf16_f32 v45, v46, v47
    v_pk_mul_f32 v[48:49], v[48:49], s[42:43]
    v_pk_mul_f32 v[50:51], v[50:51], s[42:43]
    v_cvt_pk_bf16_f32 v46, v48, v49
    v_cvt_pk_bf16_f32 v47, v50, v51
    buffer_store_dwordx4 v[44:47], v164, s[48:51], s39 offen offset:256
    s_waitcnt lgkmcnt(1)
    v_mfma_f32_16x16x32_bf16 v[52:55], v[128:131], v[100:103], v[52:55]
    v_mfma_f32_16x16x32_bf16 v[56:59], v[128:131], v[104:107], v[56:59]
    v_mfma_f32_16x16x32_bf16 v[60:63], v[128:131], v[108:111], v[60:63]
    v_mfma_f32_16x16x32_bf16 v[64:67], v[128:131], v[112:115], v[64:67]
    s_add_u32 s39, s38, 199680
    s_nop 3
    v_pk_mul_f32 v[52:53], v[52:53], s[42:43]
    v_pk_mul_f32 v[54:55], v[54:55], s[42:43]
    v_cvt_pk_bf16_f32 v52, v52, v53
    v_cvt_pk_bf16_f32 v53, v54, v55
    v_pk_mul_f32 v[56:57], v[56:57], s[42:43]
    v_pk_mul_f32 v[58:59], v[58:59], s[42:43]
    v_cvt_pk_bf16_f32 v54, v56, v57
    v_cvt_pk_bf16_f32 v55, v58, v59
    buffer_store_dwordx4 v[52:55], v164, s[48:51], s39 offen offset:0
    v_pk_mul_f32 v[60:61], v[60:61], s[42:43]
    v_pk_mul_f32 v[62:63], v[62:63], s[42:43]
    v_cvt_pk_bf16_f32 v60, v60, v61
    v_cvt_pk_bf16_f32 v61, v62, v63
    v_pk_mul_f32 v[64:65], v[64:65], s[42:43]
    v_pk_mul_f32 v[66:67], v[66:67], s[42:43]
    v_cvt_pk_bf16_f32 v62, v64, v65
    v_cvt_pk_bf16_f32 v63, v66, v67
    buffer_store_dwordx4 v[60:63], v164, s[48:51], s39 offen offset:256
RC_STD:
    v_cndmask_b32 v42, v138, 0, s[64:65]
    v_cndmask_b32 v74, 0, v138, s[64:65]
    v_cndmask_b32 v43, v138, 0, s[66:67]
    v_cndmask_b32 v75, 0, v138, s[66:67]
    v_cndmask_b32 v44, v138, 0, s[68:69]
    v_cndmask_b32 v76, 0, v138, s[68:69]
    v_cndmask_b32 v45, v138, 0, s[70:71]
    v_cndmask_b32 v77, 0, v138, s[70:71]
    v_cndmask_b32 v46, v138, 0, s[72:73]
    v_cndmask_b32 v78, 0, v138, s[72:73]
    v_cndmask_b32 v47, v138, 0, s[74:75]
    v_cndmask_b32 v79, 0, v138, s[74:75]
    v_cndmask_b32 v48, v138, 0, s[76:77]
    v_cndmask_b32 v80, 0, v138, s[76:77]
    v_cndmask_b32 v49, v138, 0, s[78:79]
    v_cndmask_b32 v81, 0, v138, s[78:79]
    v_cndmask_b32 v50, v138, 0, s[80:81]
    v_cndmask_b32 v82, 0, v138, s[80:81]
    v_cndmask_b32 v51, v138, 0, s[82:83]
    v_cndmask_b32 v83, 0, v138, s[82:83]
    v_cndmask_b32 v52, v138, 0, s[84:85]
    v_cndmask_b32 v84, 0, v138, s[84:85]
    v_cndmask_b32 v53, v138, 0, s[86:87]
    v_cndmask_b32 v85, 0, v138, s[86:87]
    v_cndmask_b32 v54, v138, 0, s[88:89]
    v_cndmask_b32 v86, 0, v138, s[88:89]
    v_cndmask_b32 v55, v138, 0, s[90:91]
    v_cndmask_b32 v87, 0, v138, s[90:91]
    v_cndmask_b32 v56, v138, 0, s[92:93]
    v_cndmask_b32 v88, 0, v138, s[92:93]
    v_cndmask_b32 v57, v138, 0, s[94:95]
    v_cndmask_b32 v89, 0, v138, s[94:95]
    s_waitcnt vmcnt(0)
    s_mov_b64 exec, 1
    ds_add_rtn_u32 v165, v1, v2 offset:4
    s_mov_b64 exec, -1
    s_waitcnt lgkmcnt(0)
    v_readfirstlane_b32 s47, v165
    s_nop 0
    s_cmp_lg_u32 s47, 3
    s_cbranch_scc1 P2_WQ
    v_mov_b32 v165, s31
    s_mov_b64 exec, 1
    s_cmp_eq_u32 s40, 1
    s_cbranch_scc1 FS_43
    buffer_store_dword v165, off, s[48:51], s37 sc1
    s_branch FS_44
FS_43:
    buffer_store_dword v165, off, s[48:51], s37
FS_44:
    s_mov_b64 exec, -1
P2_WQ:
    v_add_u32 v157, 256, v132
    s_and_b32 s40, s10, 4
    v_add_u32 v148, s40, v1
    s_add_u32 s40, s24, 16640
    s_add_u32 s39, s24, 66560
    s_mov_b32 s46, 16777216
LW_45:
    ds_read_b32 v149, v148 offset:12
    s_sub_u32 s46, s46, 1
    s_cbranch_scc1 LW_46
    s_waitcnt lgkmcnt(0)
    v_readfirstlane_b32 s47, v149
    s_nop 0
    s_cmp_ge_u32 s47, 1
    s_cbranch_scc1 LW_46
    s_sleep 1
    s_branch LW_45
LW_46:
    buffer_load_dwordx2 v[8:9], v135, s[48:51], s24 offen sc1
    buffer_load_dwordx2 v[10:11], v135, s[48:51], s40 offen sc1
    buffer_load_dwordx2 v[12:13], v136, s[48:51], s39 offen sc1
    v_and_b32 v135, 0xffffff80, v136
    v_and_b32 v148, 7, v0
    v_lshl_add_u32 v135, v148, 4, v135
    v_and_b32 v148, 8, v0
    v_add_u32 v135, v135, v148
    s_setprio 0
    s_cmp_lt_u32 s30, 4
    s_cbranch_scc1 P2_NOARR
    s_setprio 1
    s_cmp_lt_u32 s30, 6
    s_cbranch_scc1 P2_HALO
    s_mov_b64 exec, 1
    ds_add_u32 v1, v2 offset:80
    s_mov_b64 exec, -1
    s_waitcnt vmcnt(0)
    s_mov_b64 exec, 1
    ds_add_u32 v1, v2 offset:8
    s_mov_b64 exec, -1
    s_branch P2_GO
P2_HALO:
    s_cmp_eq_u32 s28, 0
    s_cbranch_scc1 P2_HARR
    s_mov_b32 s46, 16777216
LW_47:
    ds_read_b32 v149, v1 offset:8
    s_sub_u32 s46, s46, 1
    s_cbranch_scc1 LW_48
    s_waitcnt lgkmcnt(0)
    v_readfirstlane_b32 s47, v149
    s_nop 0
    s_cmp_ge_u32 s47, 2
    s_cbranch_scc1 LW_48
    s_sleep 1
    s_branch LW_47
LW_48:
    s_add_u32 m0, s58, 0
    s_add_u32 s44, s24, 2662400
    buffer_load_dwordx4 v146, s[48:51], s44 offen sc1 lds
    s_add_u32 m0, s58, 4096
    s_add_u32 s44, s24, 2679040
    buffer_load_dwordx4 v146, s[48:51], s44 offen sc1 lds
    s_add_u32 m0, s58, 8192
    s_add_u32 s44, s24, 2695680
    buffer_load_dwordx4 v146, s[48:51], s44 offen sc1 lds
    s_add_u32 m0, s58, 12288
    s_add_u32 s44, s24, 2712320
    buffer_load_dwordx4 v146, s[48:51], s44 offen sc1 lds
    s_add_u32 m0, s58, 16384
    s_add_u32 s44, s24, 2728960
    buffer_load_dwordx4 v146, s[48:51], s44 offen sc1 lds
    s_add_u32 m0, s58, 20480
    s_add_u32 s44, s24, 5324800
    buffer_load_dwordx4 v146, s[48:51], s44 offen sc1 lds
    s_add_u32 m0, s58, 24608
    s_add_u32 s44, s24, 5341440
    buffer_load_dwordx4 v146, s[48:51], s44 offen sc1 lds
    s_add_u32 m0, s58, 28736
    s_add_u32 s44, s24, 5358080
    buffer_load_dwordx4 v146, s[48:51], s44 offen sc1 lds
    s_add_u32 m0, s58, 32864
    s_add_u32 s44, s24, 5374720
    buffer_load_dwordx4 v146, s[48:51], s44 offen sc1 lds
    s_add_u32 m0, s58, 36992
    s_add_u32 s44, s24, 5391360
    buffer_load_dwordx4 v146, s[48:51], s44 offen sc1 lds
    s_mov_b64 exec, 1
    ds_add_u32 v1, v2 offset:80
    s_mov_b64 exec, -1
    s_waitcnt vmcnt(0)
    s_mov_b64 exec, 1
    ds_add_u32 v1, v2 offset:0
    s_mov_b64 exec, -1
    s_mov_b32 s46, 16777216
LW_49:
    ds_read_b32 v149, v1 offset:0
    s_sub_u32 s46, s46, 1
    s_cbranch_scc1 LW_50
    s_waitcnt lgkmcnt(0)
    v_readfirstlane_b32 s47, v149
    s_nop 0
    s_cmp_ge_u32 s47, 2
    s_cbranch_scc0 LW_49
LW_50:
    s_branch P2_GO2
P2_HARR:
    s_mov_b64 exec, 1
    ds_add_u32 v1, v2 offset:0
    s_mov_b64 exec, -1
P2_NOARR:
    s_mov_b64 exec, 1
    ds_add_u32 v1, v2 offset:80
    s_mov_b64 exec, -1
P2_GO:
    s_waitcnt vmcnt(0)
    s_mov_b32 s46, 16777216
LW_51:
    ds_read_b32 v149, v1 offset:8
    s_sub_u32 s46, s46, 1
    s_cbranch_scc1 LW_52
    s_waitcnt lgkmcnt(0)
    v_readfirstlane_b32 s47, v149
    s_nop 0
    s_cmp_ge_u32 s47, 2
    s_cbranch_scc0 LW_51
LW_52:
P2_GO2:
    ds_read2st64_b64 v[14:17], v132 offset0:4 offset1:12
    ds_read_b64 v[18:19], v133 offset:18432
    ds_read2st64_b64 v[20:23], v157 offset0:3 offset1:11
    ds_read_b64 v[24:25], v133 offset:18176
    ds_read_b64_tr_b16 v[26:27], v134 offset:22528
    ds_read_b64_tr_b16 v[28:29], v134 offset:22592
    ds_read_b64_tr_b16 v[30:31], v134 offset:22656
    ds_read_b64_tr_b16 v[32:33], v134 offset:22720
    s_waitcnt lgkmcnt(6)
    v_mfma_f32_32x32x16_bf16 v[42:57], v[14:17], v[8:11], v[42:57]
    v_mfma_f32_32x32x8_bf16 v[42:57], v[18:19], v[12:13], v[42:57]
    s_waitcnt lgkmcnt(4)
    v_mfma_f32_32x32x16_bf16 v[58:73], v[20:23], v[8:11], 0
    s_nop 9
    v_exp_f32 v42, v42
    v_exp_f32 v43, v43
    v_exp_f32 v44, v44
    v_exp_f32 v45, v45
    v_exp_f32 v46, v46
    ds_read2st64_b64 v[14:17], v132 offset0:3 offset1:11
    v_exp_f32 v47, v47
    ds_read_b64 v[18:19], v133 offset:17920
    v_exp_f32 v48, v48
    ds_read_b64_tr_b16 v[34:35], v134 offset:22272
    v_exp_f32 v49, v49
    ds_read_b64_tr_b16 v[36:37], v134 offset:22336
    v_mfma_f32_32x32x8_bf16 v[58:73], v[24:25], v[12:13], v[58:73]
    v_exp_f32 v50, v50
    v_cvt_pk_bf16_f32 v90, v42, v43
    v_cvt_pk_bf16_f32 v91, v44, v45
    v_cvt_pk_bf16_f32 v92, v46, v47
    v_cvt_pk_bf16_f32 v93, v48, v49
    v_exp_f32 v51, v51
    ds_read_b64_tr_b16 v[38:39], v134 offset:22400
    v_exp_f32 v52, v52
    ds_read_b64_tr_b16 v[40:41], v134 offset:22464
    s_waitcnt lgkmcnt(6)
    v_exp_f32 v53, v53
    v_mfma_f32_32x32x16_bf16 v[98:113], v[26:29], v[90:93], 0
    v_exp_f32 v54, v54
    v_exp_f32 v55, v55
    v_exp_f32 v56, v56
    v_exp_f32 v57, v57
    s_waitcnt lgkmcnt(4)
    v_cvt_pk_bf16_f32 v94, v50, v51
    v_cvt_pk_bf16_f32 v95, v52, v53
    v_cvt_pk_bf16_f32 v96, v54, v55
    v_cvt_pk_bf16_f32 v97, v56, v57
    v_mfma_f32_32x32x16_bf16 v[42:57], v[14:17], v[8:11], 0
    v_exp_f32 v58, v58
    v_exp_f32 v59, v59
    v_exp_f32 v60, v60
    v_exp_f32 v61, v61
    v_mfma_f32_32x32x16_bf16 v[98:113], v[30:33], v[94:97], v[98:113]
    s_cmp_eq_u32 s25, 1
    s_cbranch_scc1 HS_1
HR_1:
    v_exp_f32 v62, v62
    ds_read2st64_b64 v[20:23], v157 offset0:2 offset1:10
    v_exp_f32 v63, v63
    ds_read_b64 v[24:25], v133 offset:17664
    v_exp_f32 v64, v64
    ds_read_b64_tr_b16 v[26:27], v134 offset:22016
    v_exp_f32 v65, v65
    ds_read_b64_tr_b16 v[28:29], v134 offset:22080
    v_mfma_f32_32x32x8_bf16 v[42:57], v[18:19], v[12:13], v[42:57]
    v_exp_f32 v66, v66
    v_cvt_pk_bf16_f32 v90, v58, v59
    v_cvt_pk_bf16_f32 v91, v60, v61
    v_cvt_pk_bf16_f32 v92, v62, v63
    v_cvt_pk_bf16_f32 v93, v64, v65
    v_exp_f32 v67, v67
    ds_read_b64_tr_b16 v[30:31], v134 offset:22144
    v_exp_f32 v68, v68
    ds_read_b64_tr_b16 v[32:33], v134 offset:22208
    s_waitcnt lgkmcnt(6)
    v_exp_f32 v69, v69
    v_mfma_f32_32x32x16_bf16 v[98:113], v[34:37], v[90:93], v[98:113]
    v_exp_f32 v70, v70
    v_exp_f32 v71, v71
    v_exp_f32 v72, v72
    v_exp_f32 v73, v73
    s_waitcnt lgkmcnt(4)
    v_cvt_pk_bf16_f32 v94, v66, v67
    v_cvt_pk_bf16_f32 v95, v68, v69
    v_cvt_pk_bf16_f32 v96, v70, v71
    v_cvt_pk_bf16_f32 v97, v72, v73
    v_mfma_f32_32x32x16_bf16 v[58:73], v[20:23], v[8:11], 0
    v_exp_f32 v42, v42
    v_exp_f32 v43, v43
    v_exp_f32 v44, v44
    v_exp_f32 v45, v45
    v_mfma_f32_32x32x16_bf16 v[98:113], v[38:41], v[94:97], v[98:113]
    s_cmp_eq_u32 s25, 2
    s_cbranch_scc1 HS_2
HR_2:
    v_exp_f32 v46, v46
    ds_read2st64_b64 v[14:17], v132 offset0:2 offset1:10
    v_exp_f32 v47, v47
    ds_read_b64 v[18:19], v133 offset:17408
    v_exp_f32 v48, v48
    ds_read_b64_tr_b16 v[34:35], v134 offset:21760
    v_exp_f32 v49, v49
    ds_read_b64_tr_b16 v[36:37], v134 offset:21824
    v_mfma_f32_32x32x8_bf16 v[58:73], v[24:25], v[12:13], v[58:73]
    v_exp_f32 v50, v50
    v_cvt_pk_bf16_f32 v90, v42, v43
    v_cvt_pk_bf16_f32 v91, v44, v45
    v_cvt_pk_bf16_f32 v92, v46, v47
    v_cvt_pk_bf16_f32 v93, v48, v49
    v_exp_f32 v51, v51
    ds_read_b64_tr_b16 v[38:39], v134 offset:21888
    v_exp_f32 v52, v52
    ds_read_b64_tr_b16 v[40:41], v134 offset:21952
    s_waitcnt lgkmcnt(6)
    v_exp_f32 v53, v53
    v_mfma_f32_32x32x16_bf16 v[98:113], v[26:29], v[90:93], v[98:113]
    v_exp_f32 v54, v54
    v_exp_f32 v55, v55
    v_exp_f32 v56, v56
    v_exp_f32 v57, v57
    s_waitcnt lgkmcnt(4)
    v_cvt_pk_bf16_f32 v94, v50, v51
    v_cvt_pk_bf16_f32 v95, v52, v53
    v_cvt_pk_bf16_f32 v96, v54, v55
    v_cvt_pk_bf16_f32 v97, v56, v57
    v_mfma_f32_32x32x16_bf16 v[42:57], v[14:17], v[8:11], 0
    v_exp_f32 v58, v58
    v_exp_f32 v59, v59
    v_exp_f32 v60, v60
    v_exp_f32 v61, v61
    v_mfma_f32_32x32x16_bf16 v[98:113], v[30:33], v[94:97], v[98:113]
    s_cmp_eq_u32 s25, 3
    s_cbranch_scc1 HS_3
HR_3:
    v_exp_f32 v62, v62
    ds_read2st64_b64 v[20:23], v157 offset0:1 offset1:9
    v_exp_f32 v63, v63
    ds_read_b64 v[24:25], v133 offset:17152
    v_exp_f32 v64, v64
    ds_read_b64_tr_b16 v[26:27], v134 offset:21504
    v_exp_f32 v65, v65
    ds_read_b64_tr_b16 v[28:29], v134 offset:21568
    v_mfma_f32_32x32x8_bf16 v[42:57], v[18:19], v[12:13], v[42:57]
    v_exp_f32 v66, v66
    v_cvt_pk_bf16_f32 v90, v58, v59
    v_cvt_pk_bf16_f32 v91, v60, v61
    v_cvt_pk_bf16_f32 v92, v62, v63
    v_cvt_pk_bf16_f32 v93, v64, v65
    v_exp_f32 v67, v67
    ds_read_b64_tr_b16 v[30:31], v134 offset:21632
    v_exp_f32 v68, v68
    ds_read_b64_tr_b16 v[32:33], v134 offset:21696
    s_waitcnt lgkmcnt(6)
    v_exp_f32 v69, v69
    v_mfma_f32_32x32x16_bf16 v[98:113], v[34:37], v[90:93], v[98:113]
    v_exp_f32 v70, v70
    v_exp_f32 v71, v71
    v_exp_f32 v72, v72
    v_exp_f32 v73, v73
    s_waitcnt lgkmcnt(4)
    v_cvt_pk_bf16_f32 v94, v66, v67
    v_cvt_pk_bf16_f32 v95, v68, v69
    v_cvt_pk_bf16_f32 v96, v70, v71
    v_cvt_pk_bf16_f32 v97, v72, v73
    v_mfma_f32_32x32x16_bf16 v[58:73], v[20:23], v[8:11], 0
    v_exp_f32 v42, v42
    v_exp_f32 v43, v43
    v_exp_f32 v44, v44
    v_exp_f32 v45, v45
    v_mfma_f32_32x32x16_bf16 v[98:113], v[38:41], v[94:97], v[98:113]
    s_cmp_eq_u32 s25, 4
    s_cbranch_scc1 HS_4
HR_4:
    v_exp_f32 v46, v46
    ds_read2st64_b64 v[14:17], v132 offset0:1 offset1:9
    v_exp_f32 v47, v47
    ds_read_b64 v[18:19], v133 offset:16896
    v_exp_f32 v48, v48
    ds_read_b64_tr_b16 v[34:35], v134 offset:21248
    v_exp_f32 v49, v49
    ds_read_b64_tr_b16 v[36:37], v134 offset:21312
    v_mfma_f32_32x32x8_bf16 v[58:73], v[24:25], v[12:13], v[58:73]
    v_exp_f32 v50, v50
    v_cvt_pk_bf16_f32 v90, v42, v43
    v_cvt_pk_bf16_f32 v91, v44, v45
    v_cvt_pk_bf16_f32 v92, v46, v47
    v_cvt_pk_bf16_f32 v93, v48, v49
    v_exp_f32 v51, v51
    ds_read_b64_tr_b16 v[38:39], v134 offset:21376
    v_exp_f32 v52, v52
    ds_read_b64_tr_b16 v[40:41], v134 offset:21440
    s_waitcnt lgkmcnt(6)
    v_exp_f32 v53, v53
    v_mfma_f32_32x32x16_bf16 v[98:113], v[26:29], v[90:93], v[98:113]
    v_exp_f32 v54, v54
    v_exp_f32 v55, v55
    v_exp_f32 v56, v56
    v_exp_f32 v57, v57
    s_waitcnt lgkmcnt(4)
    v_cvt_pk_bf16_f32 v94, v50, v51
    v_cvt_pk_bf16_f32 v95, v52, v53
    v_cvt_pk_bf16_f32 v96, v54, v55
    v_cvt_pk_bf16_f32 v97, v56, v57
    v_mfma_f32_32x32x16_bf16 v[42:57], v[14:17], v[8:11], 0
    v_exp_f32 v58, v58
    v_exp_f32 v59, v59
    v_exp_f32 v60, v60
    v_exp_f32 v61, v61
    v_mfma_f32_32x32x16_bf16 v[98:113], v[30:33], v[94:97], v[98:113]
    s_cmp_eq_u32 s25, 5
    s_cbranch_scc1 HS_5
HR_5:
    v_exp_f32 v62, v62
    ds_read2st64_b64 v[20:23], v157 offset0:0 offset1:8
    v_exp_f32 v63, v63
    ds_read_b64 v[24:25], v133 offset:16640
    v_exp_f32 v64, v64
    ds_read_b64_tr_b16 v[26:27], v134 offset:20992
    v_exp_f32 v65, v65
    ds_read_b64_tr_b16 v[28:29], v134 offset:21056
    v_mfma_f32_32x32x8_bf16 v[42:57], v[18:19], v[12:13], v[42:57]
    v_exp_f32 v66, v66
    v_cvt_pk_bf16_f32 v90, v58, v59
    v_cvt_pk_bf16_f32 v91, v60, v61
    v_cvt_pk_bf16_f32 v92, v62, v63
    v_cvt_pk_bf16_f32 v93, v64, v65
    v_exp_f32 v67, v67
    ds_read_b64_tr_b16 v[30:31], v134 offset:21120
    v_exp_f32 v68, v68
    ds_read_b64_tr_b16 v[32:33], v134 offset:21184
    s_waitcnt lgkmcnt(6)
    v_exp_f32 v69, v69
    v_mfma_f32_32x32x16_bf16 v[98:113], v[34:37], v[90:93], v[98:113]
    v_exp_f32 v70, v70
    v_exp_f32 v71, v71
    v_exp_f32 v72, v72
    v_exp_f32 v73, v73
    s_waitcnt lgkmcnt(4)
    v_cvt_pk_bf16_f32 v94, v66, v67
    v_cvt_pk_bf16_f32 v95, v68, v69
    v_cvt_pk_bf16_f32 v96, v70, v71
    v_cvt_pk_bf16_f32 v97, v72, v73
    v_mfma_f32_32x32x16_bf16 v[58:73], v[20:23], v[8:11], 0
    v_exp_f32 v42, v42
    v_exp_f32 v43, v43
    v_exp_f32 v44, v44
    v_exp_f32 v45, v45
    v_mfma_f32_32x32x16_bf16 v[98:113], v[38:41], v[94:97], v[98:113]
    s_cmp_eq_u32 s25, 6
    s_cbranch_scc1 HS_6
HR_6:
    v_exp_f32 v46, v46
    ds_read2st64_b64 v[14:17], v132 offset0:0 offset1:8
    v_exp_f32 v47, v47
    ds_read_b64 v[18:19], v133 offset:16384
    v_exp_f32 v48, v48
    ds_read_b64_tr_b16 v[34:35], v134 offset:20736
    v_exp_f32 v49, v49
    ds_read_b64_tr_b16 v[36:37], v134 offset:20800
    v_mfma_f32_32x32x8_bf16 v[58:73], v[24:25], v[12:13], v[58:73]
    v_exp_f32 v50, v50
    v_cvt_pk_bf16_f32 v90, v42, v43
    v_cvt_pk_bf16_f32 v91, v44, v45
    v_cvt_pk_bf16_f32 v92, v46, v47
    v_cvt_pk_bf16_f32 v93, v48, v49
    v_exp_f32 v51, v51
    ds_read_b64_tr_b16 v[38:39], v134 offset:20864
    v_exp_f32 v52, v52
    ds_read_b64_tr_b16 v[40:41], v134 offset:20928
    s_waitcnt lgkmcnt(6)
    v_exp_f32 v53, v53
    v_mfma_f32_32x32x16_bf16 v[98:113], v[26:29], v[90:93], v[98:113]
    v_exp_f32 v54, v54
    v_exp_f32 v55, v55
    v_exp_f32 v56, v56
    v_exp_f32 v57, v57
    s_waitcnt lgkmcnt(4)
    v_cvt_pk_bf16_f32 v94, v50, v51
    v_cvt_pk_bf16_f32 v95, v52, v53
    v_cvt_pk_bf16_f32 v96, v54, v55
    v_cvt_pk_bf16_f32 v97, v56, v57
    v_mfma_f32_32x32x16_bf16 v[74:89], v[14:17], v[8:11], v[74:89]
    v_exp_f32 v58, v58
    v_exp_f32 v59, v59
    v_exp_f32 v60, v60
    v_exp_f32 v61, v61
    v_mfma_f32_32x32x16_bf16 v[98:113], v[30:33], v[94:97], v[98:113]
    s_cmp_eq_u32 s25, 7
    s_cbranch_scc1 HS_7
HR_7:
    v_exp_f32 v62, v62
    ds_read_b64_tr_b16 v[26:27], v134 offset:20480
    v_exp_f32 v63, v63
    ds_read_b64_tr_b16 v[28:29], v134 offset:20544
    v_exp_f32 v64, v64
    ds_read_b64_tr_b16 v[30:31], v134 offset:20608
    v_exp_f32 v65, v65
    ds_read_b64_tr_b16 v[32:33], v134 offset:20672
    v_mfma_f32_32x32x8_bf16 v[74:89], v[18:19], v[12:13], v[74:89]
    v_exp_f32 v66, v66
    v_cvt_pk_bf16_f32 v90, v58, v59
    v_cvt_pk_bf16_f32 v91, v60, v61
    v_cvt_pk_bf16_f32 v92, v62, v63
    v_cvt_pk_bf16_f32 v93, v64, v65
    v_exp_f32 v67, v67
    v_exp_f32 v68, v68
    s_waitcnt lgkmcnt(4)
    v_exp_f32 v69, v69
    v_mfma_f32_32x32x16_bf16 v[98:113], v[34:37], v[90:93], v[98:113]
    v_exp_f32 v70, v70
    v_exp_f32 v71, v71
    v_exp_f32 v72, v72
    v_exp_f32 v73, v73
    v_cvt_pk_bf16_f32 v94, v66, v67
    v_cvt_pk_bf16_f32 v95, v68, v69
    v_cvt_pk_bf16_f32 v96, v70, v71
    v_cvt_pk_bf16_f32 v97, v72, v73
    v_exp_f32 v74, v74
    v_exp_f32 v75, v75
    v_exp_f32 v76, v76
    v_exp_f32 v77, v77
    v_mfma_f32_32x32x16_bf16 v[98:113], v[38:41], v[94:97], v[98:113]
    s_cmp_eq_u32 s25, 8
    s_cbranch_scc1 HS_8
HR_8:
    v_exp_f32 v78, v78
    v_exp_f32 v79, v79
    v_exp_f32 v80, v80
    v_exp_f32 v81, v81
    v_exp_f32 v82, v82
    v_cvt_pk_bf16_f32 v90, v74, v75
    v_cvt_pk_bf16_f32 v91, v76, v77
    v_cvt_pk_bf16_f32 v92, v78, v79
    v_cvt_pk_bf16_f32 v93, v80, v81
    v_exp_f32 v83, v83
    v_exp_f32 v84, v84
    s_waitcnt lgkmcnt(0)
    v_exp_f32 v85, v85
    v_mfma_f32_32x32x16_bf16 v[98:113], v[26:29], v[90:93], v[98:113]
    v_exp_f32 v86, v86
    v_exp_f32 v87, v87
    v_exp_f32 v88, v88
    v_exp_f32 v89, v89
    v_cvt_pk_bf16_f32 v94, v82, v83
    v_cvt_pk_bf16_f32 v95, v84, v85
    v_cvt_pk_bf16_f32 v96, v86, v87
    v_cvt_pk_bf16_f32 v97, v88, v89
    s_nop 1
    v_mfma_f32_32x32x16_bf16 v[98:113], v[30:33], v[94:97], v[98:113]
P2_CHK:
    ds_read_b32 v149, v1 offset:32
    s_mov_b32 s40, 0x2b800000
    s_mov_b32 s41, 0x5f800000
    s_mov_b32 s42, 0x7f800000
    s_nop 8
    s_waitcnt lgkmcnt(0)
    v_rcp_f32 v150, v110
    v_pk_add_f32 v[90:91], v[98:99], v[100:101]
    v_pk_add_f32 v[92:93], v[102:103], v[104:105]
    v_pk_add_f32 v[94:95], v[106:107], v[108:109]
    v_pk_add_f32 v[90:91], v[90:91], v[92:93]
    v_cmp_nle_f32 vcc, s40, v110
    v_pk_add_f32 v[90:91], v[90:91], v[94:95]
    v_cmp_nge_f32 s[44:45], s41, v110
    v_add_f32 v90, v90, v91
    s_or_b64 vcc, vcc, s[44:45]
    v_cmp_ngt_f32 s[44:45], s42, |v90|
    s_nop 0
    s_or_b64 vcc, vcc, s[44:45]
    s_cbranch_scc1 P2_SLOW
P2_EPI:
    v_readfirstlane_b32 s40, v149
    v_pk_mul_f32 v[98:99], v[98:99], v[150:151] op_sel_hi:[1,0]
    v_pk_mul_f32 v[100:101], v[100:101], v[150:151] op_sel_hi:[1,0]
    v_pk_mul_f32 v[102:103], v[102:103], v[150:151] op_sel_hi:[1,0]
    v_pk_mul_f32 v[104:105], v[104:105], v[150:151] op_sel_hi:[1,0]
    v_pk_mul_f32 v[106:107], v[106:107], v[150:151] op_sel_hi:[1,0]
    v_pk_mul_f32 v[108:109], v[108:109], v[150:151] op_sel_hi:[1,0]
    v_cvt_pk_bf16_f32 v90, v98, v99
    v_cvt_pk_bf16_f32 v91, v100, v101
    v_cvt_pk_bf16_f32 v92, v102, v103
    v_cvt_pk_bf16_f32 v93, v104, v105
    v_cvt_pk_bf16_f32 v94, v106, v107
    v_cvt_pk_bf16_f32 v95, v108, v109
    s_cmp_eq_u32 s40, 1
    s_cbranch_scc1 P2_PL
    buffer_store_dwordx4 v[90:93], v137, s[48:51], s24 offen sc1
    buffer_store_dwordx2 v[94:95], v135, s[48:51], s39 offen sc1
    s_branch P2_STD
P2_PL:
    buffer_store_dwordx4 v[90:93], v137, s[48:51], s24 offen
    buffer_store_dwordx2 v[94:95], v135, s[48:51], s39 offen
P2_STD:
    s_mov_b64 exec, 1
    ds_add_u32 v1, v2 offset:20
    s_mov_b64 exec, -1
    s_lshl_b32 s39, s28, 3
    s_add_u32 s39, s39, s10
    s_lshl_b32 s39, s39, 5
    s_add_u32 s39, s39, s29
    s_lshl_b32 s39, s39, 2
    s_add_u32 s39, s39, 8413184
    s_lshr_b32 s41, s30, 2
    s_lshl_b32 s38, s28, 2
    s_and_b32 s43, s29, 3
    s_add_u32 s38, s38, s43
    s_lshl_b32 s38, s38, 1
    s_bfe_u32 s43, s30, 0x10001
    s_add_u32 s38, s38, s43
    s_lshl_b32 s38, s38, 7
    s_add_u32 s38, s38, 8413184
    v_and_b32 v146, 31, v0
    v_lshlrev_b32 v146, 2, v146
    s_lshl_b32 s45, s41, 4
    s_lshl_b32 s45, 0xffff, s45
    s_and_b32 s35, s45, 0xc0000000
    s_and_b32 s45, s45, 0x3fffffff
    s_lshl_b32 s44, s34, 2
    s_add_u32 s44, s44, 4
    v_lshrrev_b32 v150, 5, v0
    v_mul_u32_u24 v150, 3200, v150
    v_bfe_u32 v151, v0, 4, 1
    v_mul_u32_u24 v151, 2560, v151
    v_add3_u32 v132, v141, v150, v151
    v_add_u32 v132, 2560, v132
    v_lshrrev_b32 v150, 4, v0
    v_mul_u32_u24 v150, 80, v150
    v_add_u32 v150, v150, v1
    s_mul_i32 s43, s41, 48
    s_mov_b32 s56, s22
    s_mov_b32 s57, s23
    s_mov_b32 s58, 2621440
    s_mov_b32 s59, 0x20000
    s_lshl_b32 s36, s28, 2
    s_and_b32 s37, s29, 3
    s_add_u32 s36, s36, s37
    s_lshl_b32 s36, s36, 6
    v_sub_u32 v135, v144, v1
    v_lshl_add_u32 v135, v135, 1, v143
    v_subrev_u32 v135, 127168, v135
    s_mul_i32 s37, s30, 1408
    s_add_u32 s37, s37, 20480
    v_lshl_add_u32 v133, v0, 4, s37
    s_lshl_b32 s37, s30, 3
    s_add_u32 s36, s36, s37
    s_mul_i32 s36, s36, 1280
    s_lshr_b32 s37, s29, 2
    s_mul_i32 s37, s37, 160
    s_add_u32 s36, s36, s37
    v_mul_u32_u24 v134, 26, v0
    v_lshrrev_b32 v134, 8, v134
    v_lshl_add_u32 v133, v134, 4, v133
    v_mul_u32_u24 v134, 1120, v134
    v_lshl_add_u32 v134, v0, 4, v134
    v_add_u32 v134, s36, v134
    s_mov_b32 s36, 5120
    s_waitcnt vmcnt(0)
    v_mov_b32 v148, s31
    s_mov_b64 exec, 1
    s_cmp_eq_u32 s40, 1
    s_cbranch_scc1 FS_53
    buffer_store_dword v148, off, s[48:51], s39 sc1
    s_branch FS_54
FS_53:
    buffer_store_dword v148, off, s[48:51], s39
FS_54:
    s_mov_b64 exec, -1
    s_setprio 0
    buffer_load_dword v149, v146, s[48:51], s38 offen sc1
    s_mov_b32 s46, 16777216
LW_55:
    ds_read_b32 v148, v1 offset:24
    s_sub_u32 s46, s46, 1
    s_cbranch_scc1 LW_56
    s_waitcnt lgkmcnt(0)
    v_readfirstlane_b32 s47, v148
    s_nop 0
    s_cmp_ge_u32 s47, s44
    s_cbranch_scc1 LW_56
    s_sleep 1
    s_branch LW_55
LW_56:
    ds_read_b64_tr_b16 v[64:65], v141 offset:0
    ds_read_b64_tr_b16 v[66:67], v141 offset:1280
    ds_read_b64_tr_b16 v[68:69], v141 offset:8
    ds_read_b64_tr_b16 v[70:71], v141 offset:1288
    ds_read_b64_tr_b16 v[72:73], v141 offset:16
    ds_read_b64_tr_b16 v[74:75], v141 offset:1296
    ds_read_b64_tr_b16 v[76:77], v141 offset:24
    ds_read_b64_tr_b16 v[78:79], v141 offset:1304
    ds_read_b64_tr_b16 v[80:81], v141 offset:32
    ds_read_b64_tr_b16 v[82:83], v141 offset:1312
    s_waitcnt vmcnt(0)
    v_cmp_ne_u32 vcc, s31, v149
    s_nop 0
    s_and_b32 s44, vcc_lo, s45
    s_cbranch_scc0 P3_G1
    buffer_load_dword v149, v146, s[48:51], s38 offen sc1
    ds_read_b64_tr_b16 v[84:85], v141 offset:6400
    ds_read_b64_tr_b16 v[86:87], v141 offset:7680
    ds_read_b64_tr_b16 v[88:89], v141 offset:6408
    ds_read_b64_tr_b16 v[90:91], v141 offset:7688
    ds_read_b64_tr_b16 v[92:93], v141 offset:6416
    ds_read_b64_tr_b16 v[94:95], v141 offset:7696
    ds_read_b64_tr_b16 v[96:97], v141 offset:6424
    ds_read_b64_tr_b16 v[98:99], v141 offset:7704
    ds_read_b64_tr_b16 v[100:101], v141 offset:6432
    ds_read_b64_tr_b16 v[102:103], v141 offset:7712
    ds_read_b64_tr_b16 v[104:105], v141 offset:12800
    ds_read_b64_tr_b16 v[106:107], v141 offset:14080
    s_waitcnt vmcnt(0)
    v_cmp_ne_u32 vcc, s31, v149
    s_nop 0
    s_and_b32 s44, vcc_lo, s45
    s_cbranch_scc0 P3_G2
    buffer_load_dword v149, v146, s[48:51], s38 offen sc1
    ds_read_b64 v[164:165], v144 offset:288
    ds_read_b64 v[158:159], v143 offset:0
    ds_read_b64 v[160:161], v143 offset:8
    ds_read_b64 v[162:163], v143 offset:16
    ds_read_b64_tr_b16 v[108:109], v141 offset:12808
    ds_read_b64_tr_b16 v[110:111], v141 offset:14088
    ds_read_b64_tr_b16 v[112:113], v141 offset:12816
    ds_read_b64_tr_b16 v[114:115], v141 offset:14096
    ds_read_b64_tr_b16 v[116:117], v141 offset:12824
    ds_read_b64_tr_b16 v[118:119], v141 offset:14104
    ds_read_b64_tr_b16 v[120:121], v141 offset:12832
    ds_read_b64_tr_b16 v[122:123], v141 offset:14112
    ds_read_b64_tr_b16 v[124:125], v141 offset:19200
    ds_read_b64_tr_b16 v[126:127], v141 offset:20480
    ds_read_b64_tr_b16 v[128:129], v141 offset:19208
    ds_read_b64_tr_b16 v[130:131], v141 offset:20488
    s_mov_b32 s46, 1048576
P3_PL:
    s_waitcnt vmcnt(0)
    v_cmp_ne_u32 vcc, s31, v149
    s_nop 0
    s_and_b32 s44, vcc_lo, s45
    s_cbranch_scc0 P3_GO
    s_sub_u32 s46, s46, 1
    s_cbranch_scc1 P3_GO
    buffer_load_dword v149, v146, s[48:51], s38 offen sc1
    s_branch P3_PL
P3_G1:
    s_and_b32 s35, vcc_lo, s35
    s_mov_b32 s39, 0
    buffer_load_dwordx4 v[4:7], v139, s[48:51], s39 offen sc1
    s_mov_b32 s39, 166400
    buffer_load_dwordx4 v[8:11], v139, s[48:51], s39 offen sc1
    s_mov_b32 s39, 332800
    buffer_load_dwordx4 v[12:15], v139, s[48:51], s39 offen sc1
    s_mov_b32 s39, 499200
    buffer_load_dwordx4 v[16:19], v139, s[48:51], s39 offen sc1
    ds_read_b64_tr_b16 v[84:85], v141 offset:6400
    ds_read_b64_tr_b16 v[86:87], v141 offset:7680
    ds_read_b64_tr_b16 v[88:89], v141 offset:6408
    ds_read_b64_tr_b16 v[90:91], v141 offset:7688
    ds_read_b64_tr_b16 v[92:93], v141 offset:6416
    ds_read_b64_tr_b16 v[94:95], v141 offset:7696
    ds_read_b64_tr_b16 v[96:97], v141 offset:6424
    ds_read_b64_tr_b16 v[98:99], v141 offset:7704
    ds_read_b64_tr_b16 v[100:101], v141 offset:6432
    ds_read_b64_tr_b16 v[102:103], v141 offset:7712
    ds_read_b64_tr_b16 v[104:105], v141 offset:12800
    ds_read_b64_tr_b16 v[106:107], v141 offset:14080
    ds_read_b64 v[164:165], v144 offset:288
    ds_read_b64 v[158:159], v143 offset:0
    ds_read_b64 v[160:161], v143 offset:8
    ds_read_b64 v[162:163], v143 offset:16
    ds_read_b64_tr_b16 v[108:109], v141 offset:12808
    ds_read_b64_tr_b16 v[110:111], v141 offset:14088
    ds_read_b64_tr_b16 v[112:113], v141 offset:12816
    ds_read_b64_tr_b16 v[114:115], v141 offset:14096
    ds_read_b64_tr_b16 v[116:117], v141 offset:12824
    ds_read_b64_tr_b16 v[118:119], v141 offset:14104
    ds_read_b64_tr_b16 v[120:121], v141 offset:12832
    ds_read_b64_tr_b16 v[122:123], v141 offset:14112
    ds_read_b64_tr_b16 v[124:125], v141 offset:19200
    ds_read_b64_tr_b16 v[126:127], v141 offset:20480
    ds_read_b64_tr_b16 v[128:129], v141 offset:19208
    ds_read_b64_tr_b16 v[130:131], v141 offset:20488
    s_branch P3_GD
P3_G2:
    s_and_b32 s35, vcc_lo, s35
    s_mov_b32 s39, 0
    buffer_load_dwordx4 v[4:7], v139, s[48:51], s39 offen sc1
    s_mov_b32 s39, 166400
    buffer_load_dwordx4 v[8:11], v139, s[48:51], s39 offen sc1
    s_mov_b32 s39, 332800
    buffer_load_dwordx4 v[12:15], v139, s[48:51], s39 offen sc1
    s_mov_b32 s39, 499200
    buffer_load_dwordx4 v[16:19], v139, s[48:51], s39 offen sc1
    ds_read_b64 v[164:165], v144 offset:288
    ds_read_b64 v[158:159], v143 offset:0
    ds_read_b64 v[160:161], v143 offset:8
    ds_read_b64 v[162:163], v143 offset:16
    ds_read_b64_tr_b16 v[108:109], v141 offset:12808
    ds_read_b64_tr_b16 v[110:111], v141 offset:14088
    ds_read_b64_tr_b16 v[112:113], v141 offset:12816
    ds_read_b64_tr_b16 v[114:115], v141 offset:14096
    ds_read_b64_tr_b16 v[116:117], v141 offset:12824
    ds_read_b64_tr_b16 v[118:119], v141 offset:14104
    ds_read_b64_tr_b16 v[120:121], v141 offset:12832
    ds_read_b64_tr_b16 v[122:123], v141 offset:14112
    ds_read_b64_tr_b16 v[124:125], v141 offset:19200
    ds_read_b64_tr_b16 v[126:127], v141 offset:20480
    ds_read_b64_tr_b16 v[128:129], v141 offset:19208
    ds_read_b64_tr_b16 v[130:131], v141 offset:20488
    s_branch P3_GD
P3_GO:
    s_and_b32 s35, vcc_lo, s35
    s_mov_b32 s39, 0
    buffer_load_dwordx4 v[4:7], v139, s[48:51], s39 offen sc1
    s_mov_b32 s39, 166400
    buffer_load_dwordx4 v[8:11], v139, s[48:51], s39 offen sc1
    s_mov_b32 s39, 332800
    buffer_load_dwordx4 v[12:15], v139, s[48:51], s39 offen sc1
    s_mov_b32 s39, 499200
    buffer_load_dwordx4 v[16:19], v139, s[48:51], s39 offen sc1
P3_GD:
    s_waitcnt lgkmcnt(0)
    v_sub_f32 v166, 1.0, v164
    v_add3_u32 v165, v165, v150, s43
    v_lshlrev_b32 v152, 16, v158
    v_and_b32 v153, 0xffff0000, v158
    v_lshlrev_b32 v154, 16, v159
    v_and_b32 v155, 0xffff0000, v159
    v_lshlrev_b32 v156, 16, v160
    v_and_b32 v157, 0xffff0000, v160
    v_lshlrev_b32 v158, 16, v161
    v_and_b32 v159, 0xffff0000, v161
    v_lshlrev_b32 v160, 16, v162
    v_and_b32 v161, 0xffff0000, v162
    v_lshlrev_b32 v162, 16, v163
    v_and_b32 v163, 0xffff0000, v163
    v_pk_mul_f32 v[152:153], v[152:153], v[166:167] op_sel_hi:[1,0]
    v_pk_mul_f32 v[154:155], v[154:155], v[166:167] op_sel_hi:[1,0]
    v_pk_mul_f32 v[156:157], v[156:157], v[166:167] op_sel_hi:[1,0]
    v_pk_mul_f32 v[158:159], v[158:159], v[166:167] op_sel_hi:[1,0]
    v_pk_mul_f32 v[160:161], v[160:161], v[166:167] op_sel_hi:[1,0]
    v_pk_mul_f32 v[162:163], v[162:163], v[166:167] op_sel_hi:[1,0]
    s_waitcnt vmcnt(3)
    s_mov_b32 s39, 665600
    buffer_load_dwordx4 v[20:23], v139, s[48:51], s39 offen sc1
    v_mfma_f32_16x16x32_bf16 v[44:47], v[64:67], v[4:7], 0
    ds_read_b64_tr_b16 v[64:65], v141 offset:19216
    ds_read_b64_tr_b16 v[66:67], v141 offset:20496
    v_mfma_f32_16x16x32_bf16 v[48:51], v[68:71], v[4:7], 0
    ds_read_b64_tr_b16 v[68:69], v141 offset:19224
    ds_read_b64_tr_b16 v[70:71], v141 offset:20504
    v_mfma_f32_16x16x32_bf16 v[52:55], v[72:75], v[4:7], 0
    ds_read_b64_tr_b16 v[72:73], v141 offset:19232
    ds_read_b64_tr_b16 v[74:75], v141 offset:20512
    v_mfma_f32_16x16x32_bf16 v[56:59], v[76:79], v[4:7], 0
    ds_read_b64_tr_b16 v[76:77], v141 offset:25600
    ds_read_b64_tr_b16 v[78:79], v141 offset:26880
    v_mfma_f32_16x16x32_bf16 v[60:63], v[80:83], v[4:7], 0
    ds_read_b64_tr_b16 v[80:81], v141 offset:25608
    ds_read_b64_tr_b16 v[82:83], v141 offset:26888
    s_waitcnt vmcnt(3)
    s_mov_b32 s39, 832000
    buffer_load_dwordx4 v[24:27], v139, s[48:51], s39 offen sc1
    v_mfma_f32_16x16x32_bf16 v[44:47], v[84:87], v[8:11], v[44:47]
    ds_read_b64_tr_b16 v[84:85], v141 offset:25616
    ds_read_b64_tr_b16 v[86:87], v141 offset:26896
    v_mfma_f32_16x16x32_bf16 v[48:51], v[88:91], v[8:11], v[48:51]
    ds_read_b64_tr_b16 v[88:89], v141 offset:25624
    ds_read_b64_tr_b16 v[90:91], v141 offset:26904
    v_mfma_f32_16x16x32_bf16 v[52:55], v[92:95], v[8:11], v[52:55]
    ds_read_b64_tr_b16 v[92:93], v141 offset:25632
    ds_read_b64_tr_b16 v[94:95], v141 offset:26912
    v_mfma_f32_16x16x32_bf16 v[56:59], v[96:99], v[8:11], v[56:59]
    ds_read_b64_tr_b16 v[96:97], v141 offset:32000
    ds_read_b64_tr_b16 v[98:99], v141 offset:33280
    v_mfma_f32_16x16x32_bf16 v[60:63], v[100:103], v[8:11], v[60:63]
    ds_read_b64_tr_b16 v[100:101], v141 offset:32008
    ds_read_b64_tr_b16 v[102:103], v141 offset:33288
    s_waitcnt vmcnt(3)
    s_mov_b32 s39, 998400
    buffer_load_dwordx4 v[28:31], v139, s[48:51], s39 offen sc1
    v_mfma_f32_16x16x32_bf16 v[44:47], v[104:107], v[12:15], v[44:47]
    ds_read_b64_tr_b16 v[104:105], v141 offset:32016
    ds_read_b64_tr_b16 v[106:107], v141 offset:33296
    v_mfma_f32_16x16x32_bf16 v[48:51], v[108:111], v[12:15], v[48:51]
    ds_read_b64_tr_b16 v[108:109], v141 offset:32024
    ds_read_b64_tr_b16 v[110:111], v141 offset:33304
    v_mfma_f32_16x16x32_bf16 v[52:55], v[112:115], v[12:15], v[52:55]
    ds_read_b64_tr_b16 v[112:113], v141 offset:32032
    ds_read_b64_tr_b16 v[114:115], v141 offset:33312
    v_mfma_f32_16x16x32_bf16 v[56:59], v[116:119], v[12:15], v[56:59]
    ds_read_b64_tr_b16 v[116:117], v141 offset:38400
    ds_read_b64_tr_b16 v[118:119], v141 offset:39680
    v_mfma_f32_16x16x32_bf16 v[60:63], v[120:123], v[12:15], v[60:63]
    ds_read_b64_tr_b16 v[120:121], v141 offset:38408
    ds_read_b64_tr_b16 v[122:123], v141 offset:39688
    s_waitcnt vmcnt(3)
    s_mov_b32 s39, 0
    buffer_load_dwordx4 v[32:35], v147, s[48:51], s39 offen sc1
    buffer_load_dword v149, v146, s[48:51], s38 offen sc1
    v_mfma_f32_16x16x32_bf16 v[44:47], v[124:127], v[16:19], v[44:47]
    ds_read_b64_tr_b16 v[124:125], v141 offset:38416
    ds_read_b64_tr_b16 v[126:127], v141 offset:39696
    v_mfma_f32_16x16x32_bf16 v[48:51], v[128:131], v[16:19], v[48:51]
    ds_read_b64_tr_b16 v[128:129], v141 offset:38424
    ds_read_b64_tr_b16 v[130:131], v141 offset:39704
    s_waitcnt lgkmcnt(14)
    v_mfma_f32_16x16x32_bf16 v[52:55], v[64:67], v[16:19], v[52:55]
    ds_read_b64_tr_b16 v[64:65], v141 offset:38432
    ds_read_b64_tr_b16 v[66:67], v141 offset:39712
    v_mfma_f32_16x16x32_bf16 v[56:59], v[68:71], v[16:19], v[56:59]
    ds_read_b64_tr_b16 v[68:69], v132 offset:0
    ds_read_b64_tr_b16 v[70:71], v132 offset:12800
    v_mfma_f32_16x16x32_bf16 v[60:63], v[72:75], v[16:19], v[60:63]
    ds_read_b64_tr_b16 v[72:73], v132 offset:8
    ds_read_b64_tr_b16 v[74:75], v132 offset:12808
    s_waitcnt vmcnt(4)
    v_mfma_f32_16x16x32_bf16 v[44:47], v[76:79], v[20:23], v[44:47]
    ds_read_b64_tr_b16 v[76:77], v132 offset:16
    ds_read_b64_tr_b16 v[78:79], v132 offset:12816
    s_waitcnt lgkmcnt(14)
    v_mfma_f32_16x16x32_bf16 v[48:51], v[80:83], v[20:23], v[48:51]
    ds_read_b64_tr_b16 v[80:81], v132 offset:24
    ds_read_b64_tr_b16 v[82:83], v132 offset:12824
    v_mfma_f32_16x16x32_bf16 v[52:55], v[84:87], v[20:23], v[52:55]
    ds_read_b64_tr_b16 v[84:85], v132 offset:32
    ds_read_b64_tr_b16 v[86:87], v132 offset:12832
    v_mfma_f32_16x16x32_bf16 v[56:59], v[88:91], v[20:23], v[56:59]
    ds_read_b64_tr_b16 v[88:89], v141 offset:44800
    ds_read_b64_tr_b16 v[90:91], v141 offset:46080
    v_mfma_f32_16x16x32_bf16 v[60:63], v[92:95], v[20:23], v[60:63]
    ds_read_b64_tr_b16 v[92:93], v141 offset:44808
    ds_read_b64_tr_b16 v[94:95], v141 offset:46088
    s_waitcnt vmcnt(0)
    v_cmp_ne_u32 vcc, s31, v149
    s_mov_b32 s39, 1164800
    buffer_load_dwordx4 v[36:39], v139, s[48:51], s39 offen sc1
    s_mov_b32 s39, 665600
    buffer_load_dwordx4 v[40:43], v147, s[48:51], s39 offen sc1
    s_and_b32 s35, vcc_lo, s35
    s_waitcnt lgkmcnt(14)
    v_mfma_f32_16x16x32_bf16 v[44:47], v[96:99], v[24:27], v[44:47]
    ds_read_b64_tr_b16 v[96:97], v141 offset:44816
    ds_read_b64_tr_b16 v[98:99], v141 offset:46096
    v_mfma_f32_16x16x32_bf16 v[48:51], v[100:103], v[24:27], v[48:51]
    ds_read_b64_tr_b16 v[100:101], v141 offset:44824
    ds_read_b64_tr_b16 v[102:103], v141 offset:46104
    v_mfma_f32_16x16x32_bf16 v[52:55], v[104:107], v[24:27], v[52:55]
    ds_read_b64_tr_b16 v[104:105], v141 offset:44832
    ds_read_b64_tr_b16 v[106:107], v141 offset:46112
    v_mfma_f32_16x16x32_bf16 v[56:59], v[108:111], v[24:27], v[56:59]
    ds_read_b64_tr_b16 v[108:109], v132 offset:25600
    ds_read_b64_tr_b16 v[110:111], v132 offset:38400
    s_waitcnt lgkmcnt(14)
    v_mfma_f32_16x16x32_bf16 v[60:63], v[112:115], v[24:27], v[60:63]
    ds_read_b64_tr_b16 v[112:113], v132 offset:25608
    ds_read_b64_tr_b16 v[114:115], v132 offset:38408
    s_waitcnt vmcnt(4)
    v_mfma_f32_16x16x32_bf16 v[44:47], v[116:119], v[28:31], v[44:47]
    ds_read_b64_tr_b16 v[116:117], v132 offset:25616
    ds_read_b64_tr_b16 v[118:119], v132 offset:38416
    v_mfma_f32_16x16x32_bf16 v[48:51], v[120:123], v[28:31], v[48:51]
    ds_read_b64_tr_b16 v[120:121], v132 offset:25624
    ds_read_b64_tr_b16 v[122:123], v132 offset:38424
    v_mfma_f32_16x16x32_bf16 v[52:55], v[124:127], v[28:31], v[52:55]
    ds_read_b64_tr_b16 v[124:125], v132 offset:25632
    ds_read_b64_tr_b16 v[126:127], v132 offset:38432
    s_waitcnt lgkmcnt(14)
    v_mfma_f32_16x16x32_bf16 v[56:59], v[128:131], v[28:31], v[56:59]
    ds_read_b32 v148, v1 offset:20
    v_mfma_f32_16x16x32_bf16 v[60:63], v[64:67], v[28:31], v[60:63]
    s_waitcnt vmcnt(3)
    v_mov_b32 v150, v34
    v_mov_b32 v151, v35
    v_mov_b32_dpp v34, v32 row_ror:8 row_mask:0xf bank_mask:0x3
    v_mov_b32_dpp v35, v33 row_ror:8 row_mask:0xf bank_mask:0x3
    v_mov_b32_dpp v32, v150 row_ror:8 row_mask:0xf bank_mask:0xc
    v_mov_b32_dpp v33, v151 row_ror:8 row_mask:0xf bank_mask:0xc
    s_nop 1
    v_mfma_f32_16x16x32_bf16 v[44:47], v[68:71], v[32:35], v[44:47]
    v_mfma_f32_16x16x32_bf16 v[48:51], v[72:75], v[32:35], v[48:51]
    s_waitcnt lgkmcnt(15)
    v_mfma_f32_16x16x32_bf16 v[52:55], v[76:79], v[32:35], v[52:55]
    v_mfma_f32_16x16x32_bf16 v[56:59], v[80:83], v[32:35], v[56:59]
    v_mfma_f32_16x16x32_bf16 v[60:63], v[84:87], v[32:35], v[60:63]
    s_cmp_lg_u32 s35, 0
    s_cbranch_scc1 P3_LATE
P3_LATR:
    s_waitcnt vmcnt(1)
    v_mfma_f32_16x16x32_bf16 v[44:47], v[88:91], v[36:39], v[44:47]
    s_waitcnt lgkmcnt(15)
    v_mfma_f32_16x16x32_bf16 v[48:51], v[92:95], v[36:39], v[48:51]
    s_waitcnt lgkmcnt(15)
    v_mfma_f32_16x16x32_bf16 v[52:55], v[96:99], v[36:39], v[52:55]
    s_waitcnt lgkmcnt(13)
    v_mfma_f32_16x16x32_bf16 v[56:59], v[100:103], v[36:39], v[56:59]
    s_waitcnt lgkmcnt(11)
    v_mfma_f32_16x16x32_bf16 v[60:63], v[104:107], v[36:39], v[60:63]
    s_waitcnt vmcnt(0)
    v_mov_b32 v150, v42
    v_mov_b32 v151, v43
    v_mov_b32_dpp v42, v40 row_ror:8 row_mask:0xf bank_mask:0x3
    v_mov_b32_dpp v43, v41 row_ror:8 row_mask:0xf bank_mask:0x3
    v_mov_b32_dpp v40, v150 row_ror:8 row_mask:0xf bank_mask:0xc
    v_mov_b32_dpp v41, v151 row_ror:8 row_mask:0xf bank_mask:0xc
    s_waitcnt lgkmcnt(9)
    s_nop 0
    v_mfma_f32_16x16x32_bf16 v[44:47], v[108:111], v[40:43], v[44:47]
    s_waitcnt lgkmcnt(7)
    v_mfma_f32_16x16x32_bf16 v[48:51], v[112:115], v[40:43], v[48:51]
    s_waitcnt lgkmcnt(5)
    v_mfma_f32_16x16x32_bf16 v[52:55], v[116:119], v[40:43], v[52:55]
    s_waitcnt lgkmcnt(3)
    v_mfma_f32_16x16x32_bf16 v[56:59], v[120:123], v[40:43], v[56:59]
    s_waitcnt lgkmcnt(1)
    v_mfma_f32_16x16x32_bf16 v[60:63], v[124:127], v[40:43], v[60:63]
    s_waitcnt lgkmcnt(0)
    v_readfirstlane_b32 s47, v148
    s_nop 0
    s_cmp_ge_u32 s47, 8
    s_cbranch_scc1 P3_OK
    s_mov_b32 s46, 16777216
LW_57:
    ds_read_b32 v148, v1 offset:20
    s_sub_u32 s46, s46, 1
    s_cbranch_scc1 LW_58
    s_waitcnt lgkmcnt(0)
    v_readfirstlane_b32 s47, v148
    s_nop 0
    s_cmp_ge_u32 s47, 8
    s_cbranch_scc1 LW_58
    s_sleep 1
    s_branch LW_57
LW_58:
P3_OK:
    s_nop 1
    s_cmp_eq_u32 s41, 0
    s_cbranch_scc1 P3_H0
    ds_write_b128 v142, v[44:47] offset:0
    ds_write_b128 v142, v[48:51] offset:1024
    ds_write_b128 v142, v[52:55] offset:2048
    v_fmac_f32 v152, v56, v164
    v_fmac_f32 v153, v57, v164
    v_fmac_f32 v154, v58, v164
    v_fmac_f32 v155, v59, v164
    v_fmac_f32 v156, v60, v164
    v_fmac_f32 v157, v61, v164
    v_fmac_f32 v158, v62, v164
    v_fmac_f32 v159, v63, v164
    s_waitcnt lgkmcnt(0)
    s_barrier
    ds_read_b128 v[4:7], v142 offset:3072
    ds_read_b128 v[16:19], v165 offset:800
    ds_read_b128 v[8:11], v142 offset:4096
    ds_read_b128 v[20:23], v165 offset:816
    s_waitcnt lgkmcnt(2)
    v_fmac_f32 v152, v4, v164
    v_fmac_f32 v153, v5, v164
    v_fmac_f32 v154, v6, v164
    v_fmac_f32 v155, v7, v164
    v_fmac_f32 v152, v16, v166
    v_fmac_f32 v153, v17, v166
    v_fmac_f32 v154, v18, v166
    v_fmac_f32 v155, v19, v166
    v_cvt_pk_bf16_f32 v64, v152, v153
    v_cvt_pk_bf16_f32 v65, v154, v155
    ds_write_b64 v135, v[64:65] offset:0
    s_waitcnt lgkmcnt(0)
    v_fmac_f32 v156, v8, v164
    v_fmac_f32 v157, v9, v164
    v_fmac_f32 v158, v10, v164
    v_fmac_f32 v159, v11, v164
    v_fmac_f32 v156, v20, v166
    v_fmac_f32 v157, v21, v166
    v_fmac_f32 v158, v22, v166
    v_fmac_f32 v159, v23, v166
    v_cvt_pk_bf16_f32 v66, v156, v157
    v_cvt_pk_bf16_f32 v67, v158, v159
    ds_write_b64 v135, v[66:67] offset:8
    s_branch P3_ST
P3_H0:
    ds_write_b128 v142, v[56:59] offset:3072
    ds_write_b128 v142, v[60:63] offset:4096
    v_fmac_f32 v152, v44, v164
    v_fmac_f32 v153, v45, v164
    v_fmac_f32 v154, v46, v164
    v_fmac_f32 v155, v47, v164
    v_fmac_f32 v156, v48, v164
    v_fmac_f32 v157, v49, v164
    v_fmac_f32 v158, v50, v164
    v_fmac_f32 v159, v51, v164
    v_fmac_f32 v160, v52, v164
    v_fmac_f32 v161, v53, v164
    v_fmac_f32 v162, v54, v164
    v_fmac_f32 v163, v55, v164
    s_waitcnt lgkmcnt(0)
    s_barrier
    ds_read_b128 v[4:7], v142 offset:0
    ds_read_b128 v[16:19], v165 offset:800
    ds_read_b128 v[8:11], v142 offset:1024
    ds_read_b128 v[20:23], v165 offset:816
    ds_read_b128 v[12:15], v142 offset:2048
    ds_read_b128 v[24:27], v165 offset:832
    s_waitcnt lgkmcnt(4)
    v_fmac_f32 v152, v4, v164
    v_fmac_f32 v153, v5, v164
    v_fmac_f32 v154, v6, v164
    v_fmac_f32 v155, v7, v164
    v_fmac_f32 v152, v16, v166
    v_fmac_f32 v153, v17, v166
    v_fmac_f32 v154, v18, v166
    v_fmac_f32 v155, v19, v166
    v_cvt_pk_bf16_f32 v64, v152, v153
    v_cvt_pk_bf16_f32 v65, v154, v155
    ds_write_b64 v135, v[64:65] offset:0
    s_waitcnt lgkmcnt(2)
    v_fmac_f32 v156, v8, v164
    v_fmac_f32 v157, v9, v164
    v_fmac_f32 v158, v10, v164
    v_fmac_f32 v159, v11, v164
    v_fmac_f32 v156, v20, v166
    v_fmac_f32 v157, v21, v166
    v_fmac_f32 v158, v22, v166
    v_fmac_f32 v159, v23, v166
    v_cvt_pk_bf16_f32 v66, v156, v157
    v_cvt_pk_bf16_f32 v67, v158, v159
    ds_write_b64 v135, v[66:67] offset:8
    s_waitcnt lgkmcnt(0)
    v_fmac_f32 v160, v12, v164
    v_fmac_f32 v161, v13, v164
    v_fmac_f32 v162, v14, v164
    v_fmac_f32 v163, v15, v164
    v_fmac_f32 v160, v24, v166
    v_fmac_f32 v161, v25, v166
    v_fmac_f32 v162, v26, v166
    v_fmac_f32 v163, v27, v166
    v_cvt_pk_bf16_f32 v68, v160, v161
    v_cvt_pk_bf16_f32 v69, v162, v163
    ds_write_b64 v135, v[68:69] offset:16
P3_ST:
    s_waitcnt lgkmcnt(0)
    s_barrier
    s_mov_b32 exec_hi, 0xff
    ds_read_b128 v[4:7], v133
    ds_read_b128 v[8:11], v133 offset:704
    s_waitcnt lgkmcnt(1)
    buffer_store_dwordx4 v[4:7], v134, s[56:59], 0 offen sc1
    s_waitcnt lgkmcnt(0)
    buffer_store_dwordx4 v[8:11], v134, s[56:59], s36 offen sc1
    s_mov_b64 exec, -1
    s_endpgm
P3_LATE:
    s_mov_b32 exec_lo, s35
    s_mov_b32 exec_hi, 0
    s_mov_b32 s46, 1048576
PF_59:
    buffer_load_dword v149, v146, s[48:51], s38 offen sc1
    s_sub_u32 s46, s46, 1
    s_cbranch_scc1 PF_60
    s_waitcnt vmcnt(0)
    v_cmp_ne_u32 vcc, s31, v149
    s_cbranch_vccnz PF_59
PF_60:
    s_waitcnt vmcnt(0)
    s_mov_b64 exec, -1
    s_mov_b32 s39, 1164800
    buffer_load_dwordx4 v[36:39], v139, s[48:51], s39 offen sc1
    s_mov_b32 s39, 665600
    buffer_load_dwordx4 v[40:43], v147, s[48:51], s39 offen sc1
    s_branch P3_LATR
HS_1:
    s_cmp_eq_u32 s28, 0
    s_cbranch_scc1 P2_CHK
    s_mov_b32 s46, 16777216
LW_61:
    ds_read_b32 v149, v1 offset:0
    s_sub_u32 s46, s46, 1
    s_cbranch_scc1 LW_62
    s_waitcnt lgkmcnt(0)
    v_readfirstlane_b32 s47, v149
    s_nop 0
    s_cmp_ge_u32 s47, 2
    s_cbranch_scc1 LW_62
    s_sleep 1
    s_branch LW_61
LW_62:
    s_branch HR_1
HS_2:
    s_cmp_eq_u32 s28, 0
    s_cbranch_scc1 P2_CHK
    s_mov_b32 s46, 16777216
LW_63:
    ds_read_b32 v149, v1 offset:0
    s_sub_u32 s46, s46, 1
    s_cbranch_scc1 LW_64
    s_waitcnt lgkmcnt(0)
    v_readfirstlane_b32 s47, v149
    s_nop 0
    s_cmp_ge_u32 s47, 2
    s_cbranch_scc1 LW_64
    s_sleep 1
    s_branch LW_63
LW_64:
    s_branch HR_2
HS_3:
    s_cmp_eq_u32 s28, 0
    s_cbranch_scc1 P2_CHK
    s_mov_b32 s46, 16777216
LW_65:
    ds_read_b32 v149, v1 offset:0
    s_sub_u32 s46, s46, 1
    s_cbranch_scc1 LW_66
    s_waitcnt lgkmcnt(0)
    v_readfirstlane_b32 s47, v149
    s_nop 0
    s_cmp_ge_u32 s47, 2
    s_cbranch_scc1 LW_66
    s_sleep 1
    s_branch LW_65
LW_66:
    s_branch HR_3
HS_4:
    s_cmp_eq_u32 s28, 0
    s_cbranch_scc1 P2_CHK
    s_mov_b32 s46, 16777216
LW_67:
    ds_read_b32 v149, v1 offset:0
    s_sub_u32 s46, s46, 1
    s_cbranch_scc1 LW_68
    s_waitcnt lgkmcnt(0)
    v_readfirstlane_b32 s47, v149
    s_nop 0
    s_cmp_ge_u32 s47, 2
    s_cbranch_scc1 LW_68
    s_sleep 1
    s_branch LW_67
LW_68:
    s_branch HR_4
HS_5:
    s_cmp_eq_u32 s28, 0
    s_cbranch_scc1 P2_CHK
    s_mov_b32 s46, 16777216
LW_69:
    ds_read_b32 v149, v1 offset:0
    s_sub_u32 s46, s46, 1
    s_cbranch_scc1 LW_70
    s_waitcnt lgkmcnt(0)
    v_readfirstlane_b32 s47, v149
    s_nop 0
    s_cmp_ge_u32 s47, 2
    s_cbranch_scc1 LW_70
    s_sleep 1
    s_branch LW_69
LW_70:
    s_branch HR_5
HS_6:
    s_cmp_eq_u32 s28, 0
    s_cbranch_scc1 P2_CHK
    s_mov_b32 s46, 16777216
LW_71:
    ds_read_b32 v149, v1 offset:0
    s_sub_u32 s46, s46, 1
    s_cbranch_scc1 LW_72
    s_waitcnt lgkmcnt(0)
    v_readfirstlane_b32 s47, v149
    s_nop 0
    s_cmp_ge_u32 s47, 2
    s_cbranch_scc1 LW_72
    s_sleep 1
    s_branch LW_71
LW_72:
    s_branch HR_6
HS_7:
    s_cmp_eq_u32 s28, 0
    s_cbranch_scc1 P2_CHK
    s_branch HR_7
HS_8:
    s_cmp_eq_u32 s28, 0
    s_cbranch_scc1 P2_CHK
    s_branch HR_8
P2_SLOW:
    s_mov_b32 s46, 16777216
LW_73:
    ds_read_b32 v149, v1 offset:0
    s_sub_u32 s46, s46, 1
    s_cbranch_scc1 LW_74
    s_waitcnt lgkmcnt(0)
    v_readfirstlane_b32 s47, v149
    s_nop 0
    s_cmp_ge_u32 s47, 2
    s_cbranch_scc1 LW_74
    s_sleep 1
    s_branch LW_73
LW_74:
    s_waitcnt lgkmcnt(0)
    s_nop 15
    v_mov_b32 v152, v138
    v_mov_b32 v153, 0
    s_mov_b32 s43, 0
SL_PASS:
    v_mov_b32 v154, v132
    v_mov_b32 v155, v133
    v_mov_b32 v156, v134
    s_mov_b32 s40, 0
    v_mov_b32 v98, 0
    v_mov_b32 v99, 0
    v_mov_b32 v100, 0
    v_mov_b32 v101, 0
    v_mov_b32 v102, 0
    v_mov_b32 v103, 0
    v_mov_b32 v104, 0
    v_mov_b32 v105, 0
    v_mov_b32 v106, 0
    v_mov_b32 v107, 0
    v_mov_b32 v108, 0
    v_mov_b32 v109, 0
    v_mov_b32 v110, 0
    v_mov_b32 v111, 0
    v_mov_b32 v112, 0
    v_mov_b32 v113, 0
SL_BLK:
    ds_read_b64 v[14:15], v154 offset:2048
    ds_read_b64 v[16:17], v154 offset:6144
    ds_read_b64 v[18:19], v155 offset:18432
    ds_read_b64_tr_b16 v[26:27], v156 offset:22528
    ds_read_b64_tr_b16 v[28:29], v156 offset:22592
    ds_read_b64_tr_b16 v[30:31], v156 offset:22656
    ds_read_b64_tr_b16 v[32:33], v156 offset:22720
    v_mov_b32 v90, v153
    v_mov_b32 v91, v153
    s_cmp_lg_u32 s40, 0
    s_cbranch_scc1 SL_N0
    v_mov_b32 v90, v138
SL_N0:
    s_cmp_lg_u32 s40, 8
    s_cbranch_scc1 SL_N8
    v_mov_b32 v91, v138
SL_N8:
    v_cndmask_b32 v42, v90, v91, s[64:65]
    v_cndmask_b32 v43, v90, v91, s[66:67]
    v_cndmask_b32 v44, v90, v91, s[68:69]
    v_cndmask_b32 v45, v90, v91, s[70:71]
    v_cndmask_b32 v46, v90, v91, s[72:73]
    v_cndmask_b32 v47, v90, v91, s[74:75]
    v_cndmask_b32 v48, v90, v91, s[76:77]
    v_cndmask_b32 v49, v90, v91, s[78:79]
    v_cndmask_b32 v50, v90, v91, s[80:81]
    v_cndmask_b32 v51, v90, v91, s[82:83]
    v_cndmask_b32 v52, v90, v91, s[84:85]
    v_cndmask_b32 v53, v90, v91, s[86:87]
    v_cndmask_b32 v54, v90, v91, s[88:89]
    v_cndmask_b32 v55, v90, v91, s[90:91]
    v_cndmask_b32 v56, v90, v91, s[92:93]
    v_cndmask_b32 v57, v90, v91, s[94:95]
    s_waitcnt lgkmcnt(0)
    s_nop 0
    v_mfma_f32_32x32x16_bf16 v[42:57], v[14:17], v[8:11], v[42:57]
    v_mfma_f32_32x32x8_bf16 v[42:57], v[18:19], v[12:13], v[42:57]
    v_subrev_u32 v154, 256, v154
    v_subrev_u32 v155, 256, v155
    v_subrev_u32 v156, 256, v156
    s_nop 15
    s_cmp_lg_u32 s43, 0
    s_cbranch_scc1 SL_P2
    v_max3_f32 v152, v42, v43, v152
    v_max3_f32 v152, v44, v45, v152
    v_max3_f32 v152, v46, v47, v152
    v_max3_f32 v152, v48, v49, v152
    v_max3_f32 v152, v50, v51, v152
    v_max3_f32 v152, v52, v53, v152
    v_max3_f32 v152, v54, v55, v152
    v_max3_f32 v152, v56, v57, v152
    s_branch SL_NEXT
SL_P2:
    v_exp_f32 v42, v42
    v_exp_f32 v43, v43
    v_exp_f32 v44, v44
    v_exp_f32 v45, v45
    v_exp_f32 v46, v46
    v_exp_f32 v47, v47
    v_exp_f32 v48, v48
    v_exp_f32 v49, v49
    v_exp_f32 v50, v50
    v_exp_f32 v51, v51
    v_exp_f32 v52, v52
    v_exp_f32 v53, v53
    v_exp_f32 v54, v54
    v_exp_f32 v55, v55
    v_exp_f32 v56, v56
    v_exp_f32 v57, v57
    v_cvt_pk_bf16_f32 v90, v42, v43
    v_cvt_pk_bf16_f32 v91, v44, v45
    v_cvt_pk_bf16_f32 v92, v46, v47
    v_cvt_pk_bf16_f32 v93, v48, v49
    v_cvt_pk_bf16_f32 v94, v50, v51
    v_cvt_pk_bf16_f32 v95, v52, v53
    v_cvt_pk_bf16_f32 v96, v54, v55
    v_cvt_pk_bf16_f32 v97, v56, v57
    v_mfma_f32_32x32x16_bf16 v[98:113], v[26:29], v[90:93], v[98:113]
    s_nop 0
    v_mfma_f32_32x32x16_bf16 v[98:113], v[30:33], v[94:97], v[98:113]
    s_nop 15
SL_NEXT:
    s_add_u32 s40, s40, 1
    s_cmp_lt_u32 s40, s11
    s_cbranch_scc1 SL_BLK
    s_cmp_lg_u32 s43, 0
    s_cbranch_scc1 SL_DONE
    v_mov_b32 v153, v152
    s_nop 1
    v_permlane32_swap_b32 v152, v153
    v_max_f32 v152, v152, v153
    v_sub_f32 v153, 0, v152
    s_mov_b32 s43, 1
    s_branch SL_PASS
SL_DONE:
    ds_read_b32 v149, v1 offset:32
    v_rcp_f32 v150, v110
    s_waitcnt lgkmcnt(0)
    s_branch P2_EPI
K_END:
    s_endpgm
.section .rodata,"a"
.p2align 6
.amdhsa_kernel gated_mix__sliding_block__moe_arch_mod__prompt_kernel
  .amdhsa_next_free_vgpr 168
  .amdhsa_next_free_sgpr 102
  .amdhsa_accum_offset 168
  .amdhsa_group_segment_fixed_size 0
  .amdhsa_kernarg_size 96
  .amdhsa_user_sgpr_count 2
  .amdhsa_user_sgpr_kernarg_segment_ptr 1
  .amdhsa_system_sgpr_workgroup_id_x 1
.end_amdhsa_kernel
```
